```python
import torch

def _softmax(x, axis=-1):
    return torch.softmax(x, dim=axis)
def _gelu(x):
    return torch.nn.functional.gelu(x, approximate="tanh")
def _silu(x):
    return torch.nn.functional.silu(x)
def _sigmoid(x):
    return torch.sigmoid(x)
def _layernorm(x, axis=-1, eps=1e-5):
    m = x.mean(dim=axis, keepdim=True)
    v = x.var(dim=axis, keepdim=True, unbiased=False)
    return (x - m) / torch.sqrt(v + eps)
def _scatter_add(tgt, idx, src, axis=0):
    return tgt.clone().index_add_(axis, idx, src)
def _segment_sum(src, seg, n):
    out = torch.zeros((n,) + src.shape[1:], dtype=src.dtype)
    return out.index_add_(0, seg, src)
def _pad(x, pw):
    flat = tuple(v for pair in reversed(pw) for v in pair)
    return torch.nn.functional.pad(x, flat)

kernel_name = 'standalone__groupnorm__prompt'

def setup_inputs():

    _w = (lambda a: (lambda t: t.to(torch.bfloat16) if t.is_floating_point() else t)(torch.as_tensor(a)))
    B = 1
    G = 32
    cpg = max(1, 448 // G)
    C = G * cpg
    H, W = 16, 4096
    return {
        "x": _w(abs((lambda *s: torch.randn(*s, dtype=torch.bfloat16) * 0.05)(B, C, H, W))),
        "g": _w((lambda *s: torch.randn(*s, dtype=torch.bfloat16) * 0.05)(C) + 1.0),
        "b": _w((lambda *s: torch.randn(*s, dtype=torch.bfloat16) * 0.4)(C)),
    }

def reference(x, g, b):
    G = 32
    B, C, H, W = x.shape[0], x.shape[1], x.shape[2], x.shape[3]
    xr = x.reshape(B, G, C // G, H, W)
    mu = xr.mean(axis=(2, 3, 4), keepdims=True)
    var = ((xr - mu) ** 2).mean(axis=(2, 3, 4), keepdims=True)
    xn = (xr - mu) / torch.sqrt(var + 1e-5)
    xn = xn.reshape(B, C, H, W)
    return xn * g[None, :, None, None] + b[None, :, None, None]
```

```asm
; @launch grid=(256,1,1) block=(576,1,1) lds=2048
.amdgcn_target "amdgcn-amd-amdhsa--gfx950"
.text
.globl standalone__groupnorm__prompt_kernel
.p2align 8
.type standalone__groupnorm__prompt_kernel,@function
standalone__groupnorm__prompt_kernel:
    s_load_dwordx2 s[16:17], s[0:1], 0
    s_lshr_b32 s41, s2, 4
    s_and_b32 s38, s2, 15
    v_readfirstlane_b32 s36, v0
    s_mul_i32 s24, s41, 1835008
    s_lshl_b32 s3, s38, 13
    s_add_u32 s3, s3, s24
    v_lshl_add_u32 v1, v0, 4, s3
    s_mov_b32 s18, 58720256
    s_mov_b32 s19, 0x20000
    s_cmpk_ge_u32 s2, 256
    s_cbranch_scc1 L_end
    s_cmpk_ge_u32 s36, 512
    s_cbranch_scc1 L_svc0
    v_xor_b32 v148, 0x2000, v1
    s_waitcnt lgkmcnt(0)
    buffer_load_dwordx4 v[32:35], v1, s[16:19], 0 offen nt
    s_mov_b32 s3, 131072
    buffer_load_dwordx4 v[36:39], v148, s[16:19], s3 offen nt
    s_mov_b32 s3, 262144
    buffer_load_dwordx4 v[40:43], v1, s[16:19], s3 offen nt
    s_mov_b32 s3, 393216
    buffer_load_dwordx4 v[44:47], v148, s[16:19], s3 offen nt
    s_mov_b32 s3, 524288
    buffer_load_dwordx4 v[48:51], v1, s[16:19], s3 offen nt
    s_mov_b32 s3, 655360
    buffer_load_dwordx4 v[52:55], v148, s[16:19], s3 offen nt
    s_load_dwordx2 s[20:21], s[0:1], 24
    s_mov_b32 s40, 0xffff0000
    s_mov_b32 s22, 58720256
    s_mov_b32 s23, 0x20000
    s_mov_b32 s43, 0x39088889
    s_bitcmp1_b32 s38, 0
    s_cselect_b32 s43, 0x391d89d9, s43
    s_lshr_b32 s3, s36, 3
    v_mov_b32 v4, s3
    v_mov_b32 v5, 0
    v_mov_b32 v6, 1
    v_and_b32 v0, 63, v0
    v_lshlrev_b32 v0, 3, v0
    s_branch L_bar
L_svc0:
    v_mov_b32 v4, 0
    v_mov_b32 v5, 0
    ds_write_b64 v4, v[4:5] offset:256
    ds_write_b64 v4, v[4:5] offset:272
    s_waitcnt lgkmcnt(0)
    s_barrier
    s_branch L_service
L_bar:
    s_barrier
    s_waitcnt vmcnt(5)
    s_mov_b32 s3, 786432
    buffer_load_dwordx4 v[56:59], v1, s[16:19], s3 offen nt
    v_readfirstlane_b32 s46, v32
    v_lshlrev_b32 v16, 16, v32
    v_and_b32 v17, s40, v32
    s_lshl_b32 s46, s46, 16
    v_lshlrev_b32 v18, 16, v33
    v_and_b32 v19, s40, v33
    v_lshlrev_b32 v20, 16, v34
    v_and_b32 v21, s40, v34
    v_lshlrev_b32 v22, 16, v35
    v_and_b32 v23, s40, v35
    v_pk_add_f32 v[8:9], v[16:17], s[46:47] op_sel_hi:[1,0] neg_lo:[0,1] neg_hi:[0,1]
    v_pk_add_f32 v[10:11], v[18:19], s[46:47] op_sel_hi:[1,0] neg_lo:[0,1] neg_hi:[0,1]
    v_pk_add_f32 v[20:21], v[20:21], s[46:47] op_sel_hi:[1,0] neg_lo:[0,1] neg_hi:[0,1]
    v_pk_add_f32 v[22:23], v[22:23], s[46:47] op_sel_hi:[1,0] neg_lo:[0,1] neg_hi:[0,1]
    v_pk_mul_f32 v[12:13], v[8:9], v[8:9]
    v_pk_mul_f32 v[14:15], v[10:11], v[10:11]
    v_pk_add_f32 v[8:9], v[8:9], v[20:21]
    v_pk_fma_f32 v[12:13], v[20:21], v[20:21], v[12:13]
    v_pk_add_f32 v[10:11], v[10:11], v[22:23]
    v_pk_fma_f32 v[14:15], v[22:23], v[22:23], v[14:15]
    s_waitcnt vmcnt(5)
    s_mov_b32 s3, 917504
    buffer_load_dwordx4 v[60:63], v148, s[16:19], s3 offen nt
    v_lshlrev_b32 v16, 16, v36
    v_and_b32 v17, s40, v36
    v_lshlrev_b32 v18, 16, v37
    v_and_b32 v19, s40, v37
    v_lshlrev_b32 v20, 16, v38
    v_and_b32 v21, s40, v38
    v_lshlrev_b32 v22, 16, v39
    v_and_b32 v23, s40, v39
    v_pk_add_f32 v[16:17], v[16:17], s[46:47] op_sel_hi:[1,0] neg_lo:[0,1] neg_hi:[0,1]
    v_pk_add_f32 v[18:19], v[18:19], s[46:47] op_sel_hi:[1,0] neg_lo:[0,1] neg_hi:[0,1]
    v_pk_add_f32 v[20:21], v[20:21], s[46:47] op_sel_hi:[1,0] neg_lo:[0,1] neg_hi:[0,1]
    v_pk_add_f32 v[22:23], v[22:23], s[46:47] op_sel_hi:[1,0] neg_lo:[0,1] neg_hi:[0,1]
    v_pk_add_f32 v[8:9], v[8:9], v[16:17]
    v_pk_fma_f32 v[12:13], v[16:17], v[16:17], v[12:13]
    v_pk_add_f32 v[10:11], v[10:11], v[18:19]
    v_pk_fma_f32 v[14:15], v[18:19], v[18:19], v[14:15]
    v_pk_add_f32 v[8:9], v[8:9], v[20:21]
    v_pk_fma_f32 v[12:13], v[20:21], v[20:21], v[12:13]
    v_pk_add_f32 v[10:11], v[10:11], v[22:23]
    v_pk_fma_f32 v[14:15], v[22:23], v[22:23], v[14:15]
    s_waitcnt vmcnt(5)
    s_mov_b32 s3, 1048576
    buffer_load_dwordx4 v[64:67], v1, s[16:19], s3 offen nt
    v_lshlrev_b32 v16, 16, v40
    v_and_b32 v17, s40, v40
    v_lshlrev_b32 v18, 16, v41
    v_and_b32 v19, s40, v41
    v_lshlrev_b32 v20, 16, v42
    v_and_b32 v21, s40, v42
    v_lshlrev_b32 v22, 16, v43
    v_and_b32 v23, s40, v43
    v_pk_add_f32 v[16:17], v[16:17], s[46:47] op_sel_hi:[1,0] neg_lo:[0,1] neg_hi:[0,1]
    v_pk_add_f32 v[18:19], v[18:19], s[46:47] op_sel_hi:[1,0] neg_lo:[0,1] neg_hi:[0,1]
    v_pk_add_f32 v[20:21], v[20:21], s[46:47] op_sel_hi:[1,0] neg_lo:[0,1] neg_hi:[0,1]
    v_pk_add_f32 v[22:23], v[22:23], s[46:47] op_sel_hi:[1,0] neg_lo:[0,1] neg_hi:[0,1]
    v_pk_add_f32 v[8:9], v[8:9], v[16:17]
    v_pk_fma_f32 v[12:13], v[16:17], v[16:17], v[12:13]
    v_pk_add_f32 v[10:11], v[10:11], v[18:19]
    v_pk_fma_f32 v[14:15], v[18:19], v[18:19], v[14:15]
    v_pk_add_f32 v[8:9], v[8:9], v[20:21]
    v_pk_fma_f32 v[12:13], v[20:21], v[20:21], v[12:13]
    v_pk_add_f32 v[10:11], v[10:11], v[22:23]
    v_pk_fma_f32 v[14:15], v[22:23], v[22:23], v[14:15]
    s_waitcnt vmcnt(5)
    s_mov_b32 s3, 1179648
    buffer_load_dwordx4 v[68:71], v148, s[16:19], s3 offen nt
    v_lshlrev_b32 v16, 16, v44
    v_and_b32 v17, s40, v44
    v_lshlrev_b32 v18, 16, v45
    v_and_b32 v19, s40, v45
    v_lshlrev_b32 v20, 16, v46
    v_and_b32 v21, s40, v46
    v_lshlrev_b32 v22, 16, v47
    v_and_b32 v23, s40, v47
    v_pk_add_f32 v[16:17], v[16:17], s[46:47] op_sel_hi:[1,0] neg_lo:[0,1] neg_hi:[0,1]
    v_pk_add_f32 v[18:19], v[18:19], s[46:47] op_sel_hi:[1,0] neg_lo:[0,1] neg_hi:[0,1]
    v_pk_add_f32 v[20:21], v[20:21], s[46:47] op_sel_hi:[1,0] neg_lo:[0,1] neg_hi:[0,1]
    v_pk_add_f32 v[22:23], v[22:23], s[46:47] op_sel_hi:[1,0] neg_lo:[0,1] neg_hi:[0,1]
    v_pk_add_f32 v[8:9], v[8:9], v[16:17]
    v_pk_fma_f32 v[12:13], v[16:17], v[16:17], v[12:13]
    v_pk_add_f32 v[10:11], v[10:11], v[18:19]
    v_pk_fma_f32 v[14:15], v[18:19], v[18:19], v[14:15]
    v_pk_add_f32 v[8:9], v[8:9], v[20:21]
    v_pk_fma_f32 v[12:13], v[20:21], v[20:21], v[12:13]
    v_pk_add_f32 v[10:11], v[10:11], v[22:23]
    v_pk_fma_f32 v[14:15], v[22:23], v[22:23], v[14:15]
    s_waitcnt vmcnt(5)
    s_mov_b32 s3, 1310720
    buffer_load_dwordx4 v[72:75], v1, s[16:19], s3 offen nt
    v_lshlrev_b32 v16, 16, v48
    v_and_b32 v17, s40, v48
    v_lshlrev_b32 v18, 16, v49
    v_and_b32 v19, s40, v49
    v_lshlrev_b32 v20, 16, v50
    v_and_b32 v21, s40, v50
    v_lshlrev_b32 v22, 16, v51
    v_and_b32 v23, s40, v51
    v_pk_add_f32 v[16:17], v[16:17], s[46:47] op_sel_hi:[1,0] neg_lo:[0,1] neg_hi:[0,1]
    v_pk_add_f32 v[18:19], v[18:19], s[46:47] op_sel_hi:[1,0] neg_lo:[0,1] neg_hi:[0,1]
    v_pk_add_f32 v[20:21], v[20:21], s[46:47] op_sel_hi:[1,0] neg_lo:[0,1] neg_hi:[0,1]
    v_pk_add_f32 v[22:23], v[22:23], s[46:47] op_sel_hi:[1,0] neg_lo:[0,1] neg_hi:[0,1]
    v_pk_add_f32 v[8:9], v[8:9], v[16:17]
    v_pk_fma_f32 v[12:13], v[16:17], v[16:17], v[12:13]
    v_pk_add_f32 v[10:11], v[10:11], v[18:19]
    v_pk_fma_f32 v[14:15], v[18:19], v[18:19], v[14:15]
    v_pk_add_f32 v[8:9], v[8:9], v[20:21]
    v_pk_fma_f32 v[12:13], v[20:21], v[20:21], v[12:13]
    v_pk_add_f32 v[10:11], v[10:11], v[22:23]
    v_pk_fma_f32 v[14:15], v[22:23], v[22:23], v[14:15]
    s_waitcnt vmcnt(5)
    s_mov_b32 s3, 1441792
    buffer_load_dwordx4 v[76:79], v148, s[16:19], s3 offen nt
    v_lshlrev_b32 v16, 16, v52
    v_and_b32 v17, s40, v52
    v_lshlrev_b32 v18, 16, v53
    v_and_b32 v19, s40, v53
    v_lshlrev_b32 v20, 16, v54
    v_and_b32 v21, s40, v54
    v_lshlrev_b32 v22, 16, v55
    v_and_b32 v23, s40, v55
    v_pk_add_f32 v[16:17], v[16:17], s[46:47] op_sel_hi:[1,0] neg_lo:[0,1] neg_hi:[0,1]
    v_pk_add_f32 v[18:19], v[18:19], s[46:47] op_sel_hi:[1,0] neg_lo:[0,1] neg_hi:[0,1]
    v_pk_add_f32 v[20:21], v[20:21], s[46:47] op_sel_hi:[1,0] neg_lo:[0,1] neg_hi:[0,1]
    v_pk_add_f32 v[22:23], v[22:23], s[46:47] op_sel_hi:[1,0] neg_lo:[0,1] neg_hi:[0,1]
    v_pk_add_f32 v[8:9], v[8:9], v[16:17]
    v_pk_fma_f32 v[12:13], v[16:17], v[16:17], v[12:13]
    v_pk_add_f32 v[10:11], v[10:11], v[18:19]
    v_pk_fma_f32 v[14:15], v[18:19], v[18:19], v[14:15]
    v_pk_add_f32 v[8:9], v[8:9], v[20:21]
    v_pk_fma_f32 v[12:13], v[20:21], v[20:21], v[12:13]
    v_pk_add_f32 v[10:11], v[10:11], v[22:23]
    v_pk_fma_f32 v[14:15], v[22:23], v[22:23], v[14:15]
    s_waitcnt vmcnt(5)
    s_mov_b32 s3, 1572864
    buffer_load_dwordx4 v[80:83], v1, s[16:19], s3 offen nt
    v_lshlrev_b32 v16, 16, v56
    v_and_b32 v17, s40, v56
    v_lshlrev_b32 v18, 16, v57
    v_and_b32 v19, s40, v57
    v_lshlrev_b32 v20, 16, v58
    v_and_b32 v21, s40, v58
    v_lshlrev_b32 v22, 16, v59
    v_and_b32 v23, s40, v59
    v_pk_add_f32 v[16:17], v[16:17], s[46:47] op_sel_hi:[1,0] neg_lo:[0,1] neg_hi:[0,1]
    v_pk_add_f32 v[18:19], v[18:19], s[46:47] op_sel_hi:[1,0] neg_lo:[0,1] neg_hi:[0,1]
    v_pk_add_f32 v[20:21], v[20:21], s[46:47] op_sel_hi:[1,0] neg_lo:[0,1] neg_hi:[0,1]
    v_pk_add_f32 v[22:23], v[22:23], s[46:47] op_sel_hi:[1,0] neg_lo:[0,1] neg_hi:[0,1]
    v_pk_add_f32 v[8:9], v[8:9], v[16:17]
    v_pk_fma_f32 v[12:13], v[16:17], v[16:17], v[12:13]
    v_pk_add_f32 v[10:11], v[10:11], v[18:19]
    v_pk_fma_f32 v[14:15], v[18:19], v[18:19], v[14:15]
    v_pk_add_f32 v[8:9], v[8:9], v[20:21]
    v_pk_fma_f32 v[12:13], v[20:21], v[20:21], v[12:13]
    v_pk_add_f32 v[10:11], v[10:11], v[22:23]
    v_pk_fma_f32 v[14:15], v[22:23], v[22:23], v[14:15]
    s_waitcnt vmcnt(5)
    s_mov_b32 s3, 1703936
    buffer_load_dwordx4 v[84:87], v148, s[16:19], s3 offen nt
    v_lshlrev_b32 v16, 16, v60
    v_and_b32 v17, s40, v60
    v_lshlrev_b32 v18, 16, v61
    v_and_b32 v19, s40, v61
    v_lshlrev_b32 v20, 16, v62
    v_and_b32 v21, s40, v62
    v_lshlrev_b32 v22, 16, v63
    v_and_b32 v23, s40, v63
    v_pk_add_f32 v[16:17], v[16:17], s[46:47] op_sel_hi:[1,0] neg_lo:[0,1] neg_hi:[0,1]
    v_pk_add_f32 v[18:19], v[18:19], s[46:47] op_sel_hi:[1,0] neg_lo:[0,1] neg_hi:[0,1]
    v_pk_add_f32 v[20:21], v[20:21], s[46:47] op_sel_hi:[1,0] neg_lo:[0,1] neg_hi:[0,1]
    v_pk_add_f32 v[22:23], v[22:23], s[46:47] op_sel_hi:[1,0] neg_lo:[0,1] neg_hi:[0,1]
    v_pk_add_f32 v[8:9], v[8:9], v[16:17]
    v_pk_fma_f32 v[12:13], v[16:17], v[16:17], v[12:13]
    v_pk_add_f32 v[10:11], v[10:11], v[18:19]
    v_pk_fma_f32 v[14:15], v[18:19], v[18:19], v[14:15]
    v_pk_add_f32 v[8:9], v[8:9], v[20:21]
    v_pk_fma_f32 v[12:13], v[20:21], v[20:21], v[12:13]
    v_pk_add_f32 v[10:11], v[10:11], v[22:23]
    v_pk_fma_f32 v[14:15], v[22:23], v[22:23], v[14:15]
    s_waitcnt vmcnt(5)
    s_mov_b32 s3, 29360128
    buffer_load_dwordx4 v[88:91], v1, s[16:19], s3 offen nt
    v_lshlrev_b32 v16, 16, v64
    v_and_b32 v17, s40, v64
    v_lshlrev_b32 v18, 16, v65
    v_and_b32 v19, s40, v65
    v_lshlrev_b32 v20, 16, v66
    v_and_b32 v21, s40, v66
    v_lshlrev_b32 v22, 16, v67
    v_and_b32 v23, s40, v67
    v_pk_add_f32 v[16:17], v[16:17], s[46:47] op_sel_hi:[1,0] neg_lo:[0,1] neg_hi:[0,1]
    v_pk_add_f32 v[18:19], v[18:19], s[46:47] op_sel_hi:[1,0] neg_lo:[0,1] neg_hi:[0,1]
    v_pk_add_f32 v[20:21], v[20:21], s[46:47] op_sel_hi:[1,0] neg_lo:[0,1] neg_hi:[0,1]
    v_pk_add_f32 v[22:23], v[22:23], s[46:47] op_sel_hi:[1,0] neg_lo:[0,1] neg_hi:[0,1]
    v_pk_add_f32 v[8:9], v[8:9], v[16:17]
    v_pk_fma_f32 v[12:13], v[16:17], v[16:17], v[12:13]
    v_pk_add_f32 v[10:11], v[10:11], v[18:19]
    v_pk_fma_f32 v[14:15], v[18:19], v[18:19], v[14:15]
    v_pk_add_f32 v[8:9], v[8:9], v[20:21]
    v_pk_fma_f32 v[12:13], v[20:21], v[20:21], v[12:13]
    v_pk_add_f32 v[10:11], v[10:11], v[22:23]
    v_pk_fma_f32 v[14:15], v[22:23], v[22:23], v[14:15]
    s_waitcnt vmcnt(5)
    s_mov_b32 s3, 29491200
    buffer_load_dwordx4 v[92:95], v148, s[16:19], s3 offen nt
    v_lshlrev_b32 v16, 16, v68
    v_and_b32 v17, s40, v68
    v_lshlrev_b32 v18, 16, v69
    v_and_b32 v19, s40, v69
    v_lshlrev_b32 v20, 16, v70
    v_and_b32 v21, s40, v70
    v_lshlrev_b32 v22, 16, v71
    v_and_b32 v23, s40, v71
    v_pk_add_f32 v[16:17], v[16:17], s[46:47] op_sel_hi:[1,0] neg_lo:[0,1] neg_hi:[0,1]
    v_pk_add_f32 v[18:19], v[18:19], s[46:47] op_sel_hi:[1,0] neg_lo:[0,1] neg_hi:[0,1]
    v_pk_add_f32 v[20:21], v[20:21], s[46:47] op_sel_hi:[1,0] neg_lo:[0,1] neg_hi:[0,1]
    v_pk_add_f32 v[22:23], v[22:23], s[46:47] op_sel_hi:[1,0] neg_lo:[0,1] neg_hi:[0,1]
    v_pk_add_f32 v[8:9], v[8:9], v[16:17]
    v_pk_fma_f32 v[12:13], v[16:17], v[16:17], v[12:13]
    v_pk_add_f32 v[10:11], v[10:11], v[18:19]
    v_pk_fma_f32 v[14:15], v[18:19], v[18:19], v[14:15]
    v_pk_add_f32 v[8:9], v[8:9], v[20:21]
    v_pk_fma_f32 v[12:13], v[20:21], v[20:21], v[12:13]
    v_pk_add_f32 v[10:11], v[10:11], v[22:23]
    v_pk_fma_f32 v[14:15], v[22:23], v[22:23], v[14:15]
    s_waitcnt vmcnt(5)
    s_mov_b32 s3, 29622272
    buffer_load_dwordx4 v[96:99], v1, s[16:19], s3 offen nt
    v_lshlrev_b32 v16, 16, v72
    v_and_b32 v17, s40, v72
    v_lshlrev_b32 v18, 16, v73
    v_and_b32 v19, s40, v73
    v_lshlrev_b32 v20, 16, v74
    v_and_b32 v21, s40, v74
    v_lshlrev_b32 v22, 16, v75
    v_and_b32 v23, s40, v75
    v_pk_add_f32 v[16:17], v[16:17], s[46:47] op_sel_hi:[1,0] neg_lo:[0,1] neg_hi:[0,1]
    v_pk_add_f32 v[18:19], v[18:19], s[46:47] op_sel_hi:[1,0] neg_lo:[0,1] neg_hi:[0,1]
    v_pk_add_f32 v[20:21], v[20:21], s[46:47] op_sel_hi:[1,0] neg_lo:[0,1] neg_hi:[0,1]
    v_pk_add_f32 v[22:23], v[22:23], s[46:47] op_sel_hi:[1,0] neg_lo:[0,1] neg_hi:[0,1]
    v_pk_add_f32 v[8:9], v[8:9], v[16:17]
    v_pk_fma_f32 v[12:13], v[16:17], v[16:17], v[12:13]
    v_pk_add_f32 v[10:11], v[10:11], v[18:19]
    v_pk_fma_f32 v[14:15], v[18:19], v[18:19], v[14:15]
    v_pk_add_f32 v[8:9], v[8:9], v[20:21]
    v_pk_fma_f32 v[12:13], v[20:21], v[20:21], v[12:13]
    v_pk_add_f32 v[10:11], v[10:11], v[22:23]
    v_pk_fma_f32 v[14:15], v[22:23], v[22:23], v[14:15]
    s_waitcnt vmcnt(5)
    s_mov_b32 s3, 29753344
    buffer_load_dwordx4 v[100:103], v148, s[16:19], s3 offen nt
    v_lshlrev_b32 v16, 16, v76
    v_and_b32 v17, s40, v76
    v_lshlrev_b32 v18, 16, v77
    v_and_b32 v19, s40, v77
    v_lshlrev_b32 v20, 16, v78
    v_and_b32 v21, s40, v78
    v_lshlrev_b32 v22, 16, v79
    v_and_b32 v23, s40, v79
    v_pk_add_f32 v[16:17], v[16:17], s[46:47] op_sel_hi:[1,0] neg_lo:[0,1] neg_hi:[0,1]
    v_pk_add_f32 v[18:19], v[18:19], s[46:47] op_sel_hi:[1,0] neg_lo:[0,1] neg_hi:[0,1]
    v_pk_add_f32 v[20:21], v[20:21], s[46:47] op_sel_hi:[1,0] neg_lo:[0,1] neg_hi:[0,1]
    v_pk_add_f32 v[22:23], v[22:23], s[46:47] op_sel_hi:[1,0] neg_lo:[0,1] neg_hi:[0,1]
    v_pk_add_f32 v[8:9], v[8:9], v[16:17]
    v_pk_fma_f32 v[12:13], v[16:17], v[16:17], v[12:13]
    v_pk_add_f32 v[10:11], v[10:11], v[18:19]
    v_pk_fma_f32 v[14:15], v[18:19], v[18:19], v[14:15]
    v_pk_add_f32 v[8:9], v[8:9], v[20:21]
    v_pk_fma_f32 v[12:13], v[20:21], v[20:21], v[12:13]
    v_pk_add_f32 v[10:11], v[10:11], v[22:23]
    v_pk_fma_f32 v[14:15], v[22:23], v[22:23], v[14:15]
    s_waitcnt vmcnt(5)
    s_mov_b32 s3, 29884416
    buffer_load_dwordx4 v[104:107], v1, s[16:19], s3 offen nt
    v_lshlrev_b32 v16, 16, v80
    v_and_b32 v17, s40, v80
    v_lshlrev_b32 v18, 16, v81
    v_and_b32 v19, s40, v81
    v_lshlrev_b32 v20, 16, v82
    v_and_b32 v21, s40, v82
    v_lshlrev_b32 v22, 16, v83
    v_and_b32 v23, s40, v83
    v_pk_add_f32 v[16:17], v[16:17], s[46:47] op_sel_hi:[1,0] neg_lo:[0,1] neg_hi:[0,1]
    v_pk_add_f32 v[18:19], v[18:19], s[46:47] op_sel_hi:[1,0] neg_lo:[0,1] neg_hi:[0,1]
    v_pk_add_f32 v[20:21], v[20:21], s[46:47] op_sel_hi:[1,0] neg_lo:[0,1] neg_hi:[0,1]
    v_pk_add_f32 v[22:23], v[22:23], s[46:47] op_sel_hi:[1,0] neg_lo:[0,1] neg_hi:[0,1]
    v_pk_add_f32 v[8:9], v[8:9], v[16:17]
    v_pk_fma_f32 v[12:13], v[16:17], v[16:17], v[12:13]
    v_pk_add_f32 v[10:11], v[10:11], v[18:19]
    v_pk_fma_f32 v[14:15], v[18:19], v[18:19], v[14:15]
    v_pk_add_f32 v[8:9], v[8:9], v[20:21]
    v_pk_fma_f32 v[12:13], v[20:21], v[20:21], v[12:13]
    v_pk_add_f32 v[10:11], v[10:11], v[22:23]
    v_pk_fma_f32 v[14:15], v[22:23], v[22:23], v[14:15]
    s_waitcnt vmcnt(5)
    s_mov_b32 s3, 30015488
    buffer_load_dwordx4 v[108:111], v148, s[16:19], s3 offen nt
    v_lshlrev_b32 v16, 16, v84
    v_and_b32 v17, s40, v84
    v_lshlrev_b32 v18, 16, v85
    v_and_b32 v19, s40, v85
    v_lshlrev_b32 v20, 16, v86
    v_and_b32 v21, s40, v86
    v_lshlrev_b32 v22, 16, v87
    v_and_b32 v23, s40, v87
    v_pk_add_f32 v[16:17], v[16:17], s[46:47] op_sel_hi:[1,0] neg_lo:[0,1] neg_hi:[0,1]
    v_pk_add_f32 v[18:19], v[18:19], s[46:47] op_sel_hi:[1,0] neg_lo:[0,1] neg_hi:[0,1]
    v_pk_add_f32 v[20:21], v[20:21], s[46:47] op_sel_hi:[1,0] neg_lo:[0,1] neg_hi:[0,1]
    v_pk_add_f32 v[22:23], v[22:23], s[46:47] op_sel_hi:[1,0] neg_lo:[0,1] neg_hi:[0,1]
    v_pk_add_f32 v[8:9], v[8:9], v[16:17]
    v_pk_fma_f32 v[12:13], v[16:17], v[16:17], v[12:13]
    v_pk_add_f32 v[10:11], v[10:11], v[18:19]
    v_pk_fma_f32 v[14:15], v[18:19], v[18:19], v[14:15]
    v_pk_add_f32 v[8:9], v[8:9], v[20:21]
    v_pk_fma_f32 v[12:13], v[20:21], v[20:21], v[12:13]
    v_pk_add_f32 v[10:11], v[10:11], v[22:23]
    v_pk_fma_f32 v[14:15], v[22:23], v[22:23], v[14:15]
    v_pk_add_f32 v[8:9], v[8:9], v[10:11]
    v_pk_add_f32 v[12:13], v[12:13], v[14:15]
    s_nop 0
    v_add_f32 v8, v8, v9
    v_add_f32 v12, v12, v13
    s_nop 0
    v_add_f32_dpp v8, v8, v8 row_shr:1 row_mask:0xf bank_mask:0xf bound_ctrl:0
    v_add_f32_dpp v12, v12, v12 row_shr:1 row_mask:0xf bank_mask:0xf bound_ctrl:0
    s_nop 0
    v_add_f32_dpp v8, v8, v8 row_shr:2 row_mask:0xf bank_mask:0xf bound_ctrl:0
    v_add_f32_dpp v12, v12, v12 row_shr:2 row_mask:0xf bank_mask:0xf bound_ctrl:0
    s_nop 0
    v_add_f32_dpp v8, v8, v8 row_shr:4 row_mask:0xf bank_mask:0xf bound_ctrl:0
    v_add_f32_dpp v12, v12, v12 row_shr:4 row_mask:0xf bank_mask:0xf bound_ctrl:0
    s_nop 0
    v_add_f32_dpp v8, v8, v8 row_shr:8 row_mask:0xf bank_mask:0xf bound_ctrl:0
    v_add_f32_dpp v12, v12, v12 row_shr:8 row_mask:0xf bank_mask:0xf bound_ctrl:0
    s_nop 0
    v_add_f32_dpp v8, v8, v8 row_bcast:15 row_mask:0xa bank_mask:0xf
    v_add_f32_dpp v12, v12, v12 row_bcast:15 row_mask:0xa bank_mask:0xf
    s_nop 0
    v_add_f32_dpp v8, v8, v8 row_bcast:31 row_mask:0xc bank_mask:0xf
    v_add_f32_dpp v12, v12, v12 row_bcast:31 row_mask:0xc bank_mask:0xf
    v_mul_f32 v9, 0x39124925, v8
    s_mov_b32 exec_lo, 0
    s_mov_b32 exec_hi, 0x80000000
    v_fma_f32 v11, -v9, v8, v12
    v_add_f32 v10, s46, v9
    ds_write_b64 v4, v[10:11] offset:0
    ds_add_u32 v5, v6 offset:256
    s_mov_b64 exec, -1
    s_waitcnt vmcnt(5)
    s_mov_b32 s3, 30146560
    buffer_load_dwordx4 v[112:115], v1, s[16:19], s3 offen nt
    v_readfirstlane_b32 s46, v88
    v_lshlrev_b32 v16, 16, v88
    v_and_b32 v17, s40, v88
    s_lshl_b32 s46, s46, 16
    v_lshlrev_b32 v18, 16, v89
    v_and_b32 v19, s40, v89
    v_lshlrev_b32 v20, 16, v90
    v_and_b32 v21, s40, v90
    v_lshlrev_b32 v22, 16, v91
    v_and_b32 v23, s40, v91
    v_pk_add_f32 v[8:9], v[16:17], s[46:47] op_sel_hi:[1,0] neg_lo:[0,1] neg_hi:[0,1]
    v_pk_add_f32 v[10:11], v[18:19], s[46:47] op_sel_hi:[1,0] neg_lo:[0,1] neg_hi:[0,1]
    v_pk_add_f32 v[20:21], v[20:21], s[46:47] op_sel_hi:[1,0] neg_lo:[0,1] neg_hi:[0,1]
    v_pk_add_f32 v[22:23], v[22:23], s[46:47] op_sel_hi:[1,0] neg_lo:[0,1] neg_hi:[0,1]
    v_pk_mul_f32 v[12:13], v[8:9], v[8:9]
    v_pk_mul_f32 v[14:15], v[10:11], v[10:11]
    v_pk_add_f32 v[8:9], v[8:9], v[20:21]
    v_pk_fma_f32 v[12:13], v[20:21], v[20:21], v[12:13]
    v_pk_add_f32 v[10:11], v[10:11], v[22:23]
    v_pk_fma_f32 v[14:15], v[22:23], v[22:23], v[14:15]
    s_waitcnt vmcnt(5)
    s_mov_b32 s3, 30277632
    buffer_load_dwordx4 v[116:119], v148, s[16:19], s3 offen nt
    v_lshlrev_b32 v16, 16, v92
    v_and_b32 v17, s40, v92
    v_lshlrev_b32 v18, 16, v93
    v_and_b32 v19, s40, v93
    v_lshlrev_b32 v20, 16, v94
    v_and_b32 v21, s40, v94
    v_lshlrev_b32 v22, 16, v95
    v_and_b32 v23, s40, v95
    v_pk_add_f32 v[16:17], v[16:17], s[46:47] op_sel_hi:[1,0] neg_lo:[0,1] neg_hi:[0,1]
    v_pk_add_f32 v[18:19], v[18:19], s[46:47] op_sel_hi:[1,0] neg_lo:[0,1] neg_hi:[0,1]
    v_pk_add_f32 v[20:21], v[20:21], s[46:47] op_sel_hi:[1,0] neg_lo:[0,1] neg_hi:[0,1]
    v_pk_add_f32 v[22:23], v[22:23], s[46:47] op_sel_hi:[1,0] neg_lo:[0,1] neg_hi:[0,1]
    v_pk_add_f32 v[8:9], v[8:9], v[16:17]
    v_pk_fma_f32 v[12:13], v[16:17], v[16:17], v[12:13]
    v_pk_add_f32 v[10:11], v[10:11], v[18:19]
    v_pk_fma_f32 v[14:15], v[18:19], v[18:19], v[14:15]
    v_pk_add_f32 v[8:9], v[8:9], v[20:21]
    v_pk_fma_f32 v[12:13], v[20:21], v[20:21], v[12:13]
    v_pk_add_f32 v[10:11], v[10:11], v[22:23]
    v_pk_fma_f32 v[14:15], v[22:23], v[22:23], v[14:15]
    s_waitcnt vmcnt(5)
    s_mov_b32 s3, 30408704
    buffer_load_dwordx4 v[120:123], v1, s[16:19], s3 offen nt
    v_lshlrev_b32 v16, 16, v96
    v_and_b32 v17, s40, v96
    v_lshlrev_b32 v18, 16, v97
    v_and_b32 v19, s40, v97
    v_lshlrev_b32 v20, 16, v98
    v_and_b32 v21, s40, v98
    v_lshlrev_b32 v22, 16, v99
    v_and_b32 v23, s40, v99
    v_pk_add_f32 v[16:17], v[16:17], s[46:47] op_sel_hi:[1,0] neg_lo:[0,1] neg_hi:[0,1]
    v_pk_add_f32 v[18:19], v[18:19], s[46:47] op_sel_hi:[1,0] neg_lo:[0,1] neg_hi:[0,1]
    v_pk_add_f32 v[20:21], v[20:21], s[46:47] op_sel_hi:[1,0] neg_lo:[0,1] neg_hi:[0,1]
    v_pk_add_f32 v[22:23], v[22:23], s[46:47] op_sel_hi:[1,0] neg_lo:[0,1] neg_hi:[0,1]
    v_pk_add_f32 v[8:9], v[8:9], v[16:17]
    v_pk_fma_f32 v[12:13], v[16:17], v[16:17], v[12:13]
    v_pk_add_f32 v[10:11], v[10:11], v[18:19]
    v_pk_fma_f32 v[14:15], v[18:19], v[18:19], v[14:15]
    v_pk_add_f32 v[8:9], v[8:9], v[20:21]
    v_pk_fma_f32 v[12:13], v[20:21], v[20:21], v[12:13]
    v_pk_add_f32 v[10:11], v[10:11], v[22:23]
    v_pk_fma_f32 v[14:15], v[22:23], v[22:23], v[14:15]
    s_waitcnt vmcnt(5)
    s_mov_b32 s3, 30539776
    buffer_load_dwordx4 v[124:127], v148, s[16:19], s3 offen nt
    v_lshlrev_b32 v16, 16, v100
    v_and_b32 v17, s40, v100
    v_lshlrev_b32 v18, 16, v101
    v_and_b32 v19, s40, v101
    v_lshlrev_b32 v20, 16, v102
    v_and_b32 v21, s40, v102
    v_lshlrev_b32 v22, 16, v103
    v_and_b32 v23, s40, v103
    v_pk_add_f32 v[16:17], v[16:17], s[46:47] op_sel_hi:[1,0] neg_lo:[0,1] neg_hi:[0,1]
    v_pk_add_f32 v[18:19], v[18:19], s[46:47] op_sel_hi:[1,0] neg_lo:[0,1] neg_hi:[0,1]
    v_pk_add_f32 v[20:21], v[20:21], s[46:47] op_sel_hi:[1,0] neg_lo:[0,1] neg_hi:[0,1]
    v_pk_add_f32 v[22:23], v[22:23], s[46:47] op_sel_hi:[1,0] neg_lo:[0,1] neg_hi:[0,1]
    v_pk_add_f32 v[8:9], v[8:9], v[16:17]
    v_pk_fma_f32 v[12:13], v[16:17], v[16:17], v[12:13]
    v_pk_add_f32 v[10:11], v[10:11], v[18:19]
    v_pk_fma_f32 v[14:15], v[18:19], v[18:19], v[14:15]
    v_pk_add_f32 v[8:9], v[8:9], v[20:21]
    v_pk_fma_f32 v[12:13], v[20:21], v[20:21], v[12:13]
    v_pk_add_f32 v[10:11], v[10:11], v[22:23]
    v_pk_fma_f32 v[14:15], v[22:23], v[22:23], v[14:15]
    s_waitcnt vmcnt(5)
    s_mov_b32 s3, 30670848
    buffer_load_dwordx4 v[128:131], v1, s[16:19], s3 offen nt
    v_lshlrev_b32 v16, 16, v104
    v_and_b32 v17, s40, v104
    v_lshlrev_b32 v18, 16, v105
    v_and_b32 v19, s40, v105
    v_lshlrev_b32 v20, 16, v106
    v_and_b32 v21, s40, v106
    v_lshlrev_b32 v22, 16, v107
    v_and_b32 v23, s40, v107
    v_pk_add_f32 v[16:17], v[16:17], s[46:47] op_sel_hi:[1,0] neg_lo:[0,1] neg_hi:[0,1]
    v_pk_add_f32 v[18:19], v[18:19], s[46:47] op_sel_hi:[1,0] neg_lo:[0,1] neg_hi:[0,1]
    v_pk_add_f32 v[20:21], v[20:21], s[46:47] op_sel_hi:[1,0] neg_lo:[0,1] neg_hi:[0,1]
    v_pk_add_f32 v[22:23], v[22:23], s[46:47] op_sel_hi:[1,0] neg_lo:[0,1] neg_hi:[0,1]
    v_pk_add_f32 v[8:9], v[8:9], v[16:17]
    v_pk_fma_f32 v[12:13], v[16:17], v[16:17], v[12:13]
    v_pk_add_f32 v[10:11], v[10:11], v[18:19]
    v_pk_fma_f32 v[14:15], v[18:19], v[18:19], v[14:15]
    v_pk_add_f32 v[8:9], v[8:9], v[20:21]
    v_pk_fma_f32 v[12:13], v[20:21], v[20:21], v[12:13]
    v_pk_add_f32 v[10:11], v[10:11], v[22:23]
    v_pk_fma_f32 v[14:15], v[22:23], v[22:23], v[14:15]
    s_waitcnt vmcnt(5)
    s_mov_b32 s3, 30801920
    buffer_load_dwordx4 v[132:135], v148, s[16:19], s3 offen nt
    v_lshlrev_b32 v16, 16, v108
    v_and_b32 v17, s40, v108
    v_lshlrev_b32 v18, 16, v109
    v_and_b32 v19, s40, v109
    v_lshlrev_b32 v20, 16, v110
    v_and_b32 v21, s40, v110
    v_lshlrev_b32 v22, 16, v111
    v_and_b32 v23, s40, v111
    v_pk_add_f32 v[16:17], v[16:17], s[46:47] op_sel_hi:[1,0] neg_lo:[0,1] neg_hi:[0,1]
    v_pk_add_f32 v[18:19], v[18:19], s[46:47] op_sel_hi:[1,0] neg_lo:[0,1] neg_hi:[0,1]
    v_pk_add_f32 v[20:21], v[20:21], s[46:47] op_sel_hi:[1,0] neg_lo:[0,1] neg_hi:[0,1]
    v_pk_add_f32 v[22:23], v[22:23], s[46:47] op_sel_hi:[1,0] neg_lo:[0,1] neg_hi:[0,1]
    v_pk_add_f32 v[8:9], v[8:9], v[16:17]
    v_pk_fma_f32 v[12:13], v[16:17], v[16:17], v[12:13]
    v_pk_add_f32 v[10:11], v[10:11], v[18:19]
    v_pk_fma_f32 v[14:15], v[18:19], v[18:19], v[14:15]
    v_pk_add_f32 v[8:9], v[8:9], v[20:21]
    v_pk_fma_f32 v[12:13], v[20:21], v[20:21], v[12:13]
    v_pk_add_f32 v[10:11], v[10:11], v[22:23]
    v_pk_fma_f32 v[14:15], v[22:23], v[22:23], v[14:15]
    s_waitcnt vmcnt(5)
    s_mov_b32 s3, 30932992
    buffer_load_dwordx4 v[136:139], v1, s[16:19], s3 offen nt
    v_lshlrev_b32 v16, 16, v112
    v_and_b32 v17, s40, v112
    v_lshlrev_b32 v18, 16, v113
    v_and_b32 v19, s40, v113
    v_lshlrev_b32 v20, 16, v114
    v_and_b32 v21, s40, v114
    v_lshlrev_b32 v22, 16, v115
    v_and_b32 v23, s40, v115
    v_pk_add_f32 v[16:17], v[16:17], s[46:47] op_sel_hi:[1,0] neg_lo:[0,1] neg_hi:[0,1]
    v_pk_add_f32 v[18:19], v[18:19], s[46:47] op_sel_hi:[1,0] neg_lo:[0,1] neg_hi:[0,1]
    v_pk_add_f32 v[20:21], v[20:21], s[46:47] op_sel_hi:[1,0] neg_lo:[0,1] neg_hi:[0,1]
    v_pk_add_f32 v[22:23], v[22:23], s[46:47] op_sel_hi:[1,0] neg_lo:[0,1] neg_hi:[0,1]
    v_pk_add_f32 v[8:9], v[8:9], v[16:17]
    v_pk_fma_f32 v[12:13], v[16:17], v[16:17], v[12:13]
    v_pk_add_f32 v[10:11], v[10:11], v[18:19]
    v_pk_fma_f32 v[14:15], v[18:19], v[18:19], v[14:15]
    v_pk_add_f32 v[8:9], v[8:9], v[20:21]
    v_pk_fma_f32 v[12:13], v[20:21], v[20:21], v[12:13]
    v_pk_add_f32 v[10:11], v[10:11], v[22:23]
    v_pk_fma_f32 v[14:15], v[22:23], v[22:23], v[14:15]
    s_bitcmp1_b32 s38, 0
    s_waitcnt vmcnt(5)
    s_cbranch_scc1 L_o21
    s_mov_b32 s3, 31064064
    buffer_load_dwordx4 v[140:143], v1, s[16:19], s3 offen nt
    s_branch L_j21
L_o21:
    s_waitcnt vmcnt(5)
L_j21:
    v_lshlrev_b32 v16, 16, v116
    v_and_b32 v17, s40, v116
    v_lshlrev_b32 v18, 16, v117
    v_and_b32 v19, s40, v117
    v_lshlrev_b32 v20, 16, v118
    v_and_b32 v21, s40, v118
    v_lshlrev_b32 v22, 16, v119
    v_and_b32 v23, s40, v119
    v_pk_add_f32 v[16:17], v[16:17], s[46:47] op_sel_hi:[1,0] neg_lo:[0,1] neg_hi:[0,1]
    v_pk_add_f32 v[18:19], v[18:19], s[46:47] op_sel_hi:[1,0] neg_lo:[0,1] neg_hi:[0,1]
    v_pk_add_f32 v[20:21], v[20:21], s[46:47] op_sel_hi:[1,0] neg_lo:[0,1] neg_hi:[0,1]
    v_pk_add_f32 v[22:23], v[22:23], s[46:47] op_sel_hi:[1,0] neg_lo:[0,1] neg_hi:[0,1]
    v_pk_add_f32 v[8:9], v[8:9], v[16:17]
    v_pk_fma_f32 v[12:13], v[16:17], v[16:17], v[12:13]
    v_pk_add_f32 v[10:11], v[10:11], v[18:19]
    v_pk_fma_f32 v[14:15], v[18:19], v[18:19], v[14:15]
    v_pk_add_f32 v[8:9], v[8:9], v[20:21]
    v_pk_fma_f32 v[12:13], v[20:21], v[20:21], v[12:13]
    v_pk_add_f32 v[10:11], v[10:11], v[22:23]
    v_pk_fma_f32 v[14:15], v[22:23], v[22:23], v[14:15]
    s_bitcmp1_b32 s38, 0
    s_waitcnt vmcnt(5)
    s_cbranch_scc1 L_o22
    s_mov_b32 s3, 31064064
    buffer_load_dwordx4 v[144:147], v148, s[16:19], s3 offen nt
    s_branch L_j22
L_o22:
    s_waitcnt vmcnt(4)
L_j22:
    v_lshlrev_b32 v16, 16, v120
    v_and_b32 v17, s40, v120
    v_lshlrev_b32 v18, 16, v121
    v_and_b32 v19, s40, v121
    v_lshlrev_b32 v20, 16, v122
    v_and_b32 v21, s40, v122
    v_lshlrev_b32 v22, 16, v123
    v_and_b32 v23, s40, v123
    v_pk_add_f32 v[16:17], v[16:17], s[46:47] op_sel_hi:[1,0] neg_lo:[0,1] neg_hi:[0,1]
    v_pk_add_f32 v[18:19], v[18:19], s[46:47] op_sel_hi:[1,0] neg_lo:[0,1] neg_hi:[0,1]
    v_pk_add_f32 v[20:21], v[20:21], s[46:47] op_sel_hi:[1,0] neg_lo:[0,1] neg_hi:[0,1]
    v_pk_add_f32 v[22:23], v[22:23], s[46:47] op_sel_hi:[1,0] neg_lo:[0,1] neg_hi:[0,1]
    v_pk_add_f32 v[8:9], v[8:9], v[16:17]
    v_pk_fma_f32 v[12:13], v[16:17], v[16:17], v[12:13]
    v_pk_add_f32 v[10:11], v[10:11], v[18:19]
    v_pk_fma_f32 v[14:15], v[18:19], v[18:19], v[14:15]
    v_pk_add_f32 v[8:9], v[8:9], v[20:21]
    v_pk_fma_f32 v[12:13], v[20:21], v[20:21], v[12:13]
    v_pk_add_f32 v[10:11], v[10:11], v[22:23]
    v_pk_fma_f32 v[14:15], v[22:23], v[22:23], v[14:15]
    s_bitcmp1_b32 s38, 0
    s_waitcnt vmcnt(5)
    s_cbranch_scc0 L_j23
    s_waitcnt vmcnt(3)
L_j23:
    v_lshlrev_b32 v16, 16, v124
    v_and_b32 v17, s40, v124
    v_lshlrev_b32 v18, 16, v125
    v_and_b32 v19, s40, v125
    v_lshlrev_b32 v20, 16, v126
    v_and_b32 v21, s40, v126
    v_lshlrev_b32 v22, 16, v127
    v_and_b32 v23, s40, v127
    v_pk_add_f32 v[16:17], v[16:17], s[46:47] op_sel_hi:[1,0] neg_lo:[0,1] neg_hi:[0,1]
    v_pk_add_f32 v[18:19], v[18:19], s[46:47] op_sel_hi:[1,0] neg_lo:[0,1] neg_hi:[0,1]
    v_pk_add_f32 v[20:21], v[20:21], s[46:47] op_sel_hi:[1,0] neg_lo:[0,1] neg_hi:[0,1]
    v_pk_add_f32 v[22:23], v[22:23], s[46:47] op_sel_hi:[1,0] neg_lo:[0,1] neg_hi:[0,1]
    v_pk_add_f32 v[8:9], v[8:9], v[16:17]
    v_pk_fma_f32 v[12:13], v[16:17], v[16:17], v[12:13]
    v_pk_add_f32 v[10:11], v[10:11], v[18:19]
    v_pk_fma_f32 v[14:15], v[18:19], v[18:19], v[14:15]
    v_pk_add_f32 v[8:9], v[8:9], v[20:21]
    v_pk_fma_f32 v[12:13], v[20:21], v[20:21], v[12:13]
    v_pk_add_f32 v[10:11], v[10:11], v[22:23]
    v_pk_fma_f32 v[14:15], v[22:23], v[22:23], v[14:15]
    s_bitcmp1_b32 s38, 0
    s_waitcnt vmcnt(4)
    s_cbranch_scc0 L_j24
    s_waitcnt vmcnt(2)
L_j24:
    v_lshlrev_b32 v16, 16, v128
    v_and_b32 v17, s40, v128
    v_lshlrev_b32 v18, 16, v129
    v_and_b32 v19, s40, v129
    v_lshlrev_b32 v20, 16, v130
    v_and_b32 v21, s40, v130
    v_lshlrev_b32 v22, 16, v131
    v_and_b32 v23, s40, v131
    v_pk_add_f32 v[16:17], v[16:17], s[46:47] op_sel_hi:[1,0] neg_lo:[0,1] neg_hi:[0,1]
    v_pk_add_f32 v[18:19], v[18:19], s[46:47] op_sel_hi:[1,0] neg_lo:[0,1] neg_hi:[0,1]
    v_pk_add_f32 v[20:21], v[20:21], s[46:47] op_sel_hi:[1,0] neg_lo:[0,1] neg_hi:[0,1]
    v_pk_add_f32 v[22:23], v[22:23], s[46:47] op_sel_hi:[1,0] neg_lo:[0,1] neg_hi:[0,1]
    v_pk_add_f32 v[8:9], v[8:9], v[16:17]
    v_pk_fma_f32 v[12:13], v[16:17], v[16:17], v[12:13]
    v_pk_add_f32 v[10:11], v[10:11], v[18:19]
    v_pk_fma_f32 v[14:15], v[18:19], v[18:19], v[14:15]
    v_pk_add_f32 v[8:9], v[8:9], v[20:21]
    v_pk_fma_f32 v[12:13], v[20:21], v[20:21], v[12:13]
    v_pk_add_f32 v[10:11], v[10:11], v[22:23]
    v_pk_fma_f32 v[14:15], v[22:23], v[22:23], v[14:15]
    s_bitcmp1_b32 s38, 0
    s_waitcnt vmcnt(3)
    s_cbranch_scc0 L_j25
    s_waitcnt vmcnt(1)
L_j25:
    v_lshlrev_b32 v16, 16, v132
    v_and_b32 v17, s40, v132
    v_lshlrev_b32 v18, 16, v133
    v_and_b32 v19, s40, v133
    v_lshlrev_b32 v20, 16, v134
    v_and_b32 v21, s40, v134
    v_lshlrev_b32 v22, 16, v135
    v_and_b32 v23, s40, v135
    v_pk_add_f32 v[16:17], v[16:17], s[46:47] op_sel_hi:[1,0] neg_lo:[0,1] neg_hi:[0,1]
    v_pk_add_f32 v[18:19], v[18:19], s[46:47] op_sel_hi:[1,0] neg_lo:[0,1] neg_hi:[0,1]
    v_pk_add_f32 v[20:21], v[20:21], s[46:47] op_sel_hi:[1,0] neg_lo:[0,1] neg_hi:[0,1]
    v_pk_add_f32 v[22:23], v[22:23], s[46:47] op_sel_hi:[1,0] neg_lo:[0,1] neg_hi:[0,1]
    v_pk_add_f32 v[8:9], v[8:9], v[16:17]
    v_pk_fma_f32 v[12:13], v[16:17], v[16:17], v[12:13]
    v_pk_add_f32 v[10:11], v[10:11], v[18:19]
    v_pk_fma_f32 v[14:15], v[18:19], v[18:19], v[14:15]
    v_pk_add_f32 v[8:9], v[8:9], v[20:21]
    v_pk_fma_f32 v[12:13], v[20:21], v[20:21], v[12:13]
    v_pk_add_f32 v[10:11], v[10:11], v[22:23]
    v_pk_fma_f32 v[14:15], v[22:23], v[22:23], v[14:15]
    s_bitcmp1_b32 s38, 0
    s_waitcnt vmcnt(2)
    s_cbranch_scc0 L_j26
    s_waitcnt vmcnt(0)
L_j26:
    v_lshlrev_b32 v16, 16, v136
    v_and_b32 v17, s40, v136
    v_lshlrev_b32 v18, 16, v137
    v_and_b32 v19, s40, v137
    v_lshlrev_b32 v20, 16, v138
    v_and_b32 v21, s40, v138
    v_lshlrev_b32 v22, 16, v139
    v_and_b32 v23, s40, v139
    v_pk_add_f32 v[16:17], v[16:17], s[46:47] op_sel_hi:[1,0] neg_lo:[0,1] neg_hi:[0,1]
    v_pk_add_f32 v[18:19], v[18:19], s[46:47] op_sel_hi:[1,0] neg_lo:[0,1] neg_hi:[0,1]
    v_pk_add_f32 v[20:21], v[20:21], s[46:47] op_sel_hi:[1,0] neg_lo:[0,1] neg_hi:[0,1]
    v_pk_add_f32 v[22:23], v[22:23], s[46:47] op_sel_hi:[1,0] neg_lo:[0,1] neg_hi:[0,1]
    v_pk_add_f32 v[8:9], v[8:9], v[16:17]
    v_pk_fma_f32 v[12:13], v[16:17], v[16:17], v[12:13]
    v_pk_add_f32 v[10:11], v[10:11], v[18:19]
    v_pk_fma_f32 v[14:15], v[18:19], v[18:19], v[14:15]
    v_pk_add_f32 v[8:9], v[8:9], v[20:21]
    v_pk_fma_f32 v[12:13], v[20:21], v[20:21], v[12:13]
    v_pk_add_f32 v[10:11], v[10:11], v[22:23]
    v_pk_fma_f32 v[14:15], v[22:23], v[22:23], v[14:15]
    s_cselect_b64 exec, 0, -1
    s_waitcnt vmcnt(1)
    v_lshlrev_b32 v16, 16, v140
    v_and_b32 v17, s40, v140
    v_lshlrev_b32 v18, 16, v141
    v_and_b32 v19, s40, v141
    v_lshlrev_b32 v20, 16, v142
    v_and_b32 v21, s40, v142
    v_lshlrev_b32 v22, 16, v143
    v_and_b32 v23, s40, v143
    v_pk_add_f32 v[16:17], v[16:17], s[46:47] op_sel_hi:[1,0] neg_lo:[0,1] neg_hi:[0,1]
    v_pk_add_f32 v[18:19], v[18:19], s[46:47] op_sel_hi:[1,0] neg_lo:[0,1] neg_hi:[0,1]
    v_pk_add_f32 v[20:21], v[20:21], s[46:47] op_sel_hi:[1,0] neg_lo:[0,1] neg_hi:[0,1]
    v_pk_add_f32 v[22:23], v[22:23], s[46:47] op_sel_hi:[1,0] neg_lo:[0,1] neg_hi:[0,1]
    v_pk_add_f32 v[8:9], v[8:9], v[16:17]
    v_pk_fma_f32 v[12:13], v[16:17], v[16:17], v[12:13]
    v_pk_add_f32 v[10:11], v[10:11], v[18:19]
    v_pk_fma_f32 v[14:15], v[18:19], v[18:19], v[14:15]
    v_pk_add_f32 v[8:9], v[8:9], v[20:21]
    v_pk_fma_f32 v[12:13], v[20:21], v[20:21], v[12:13]
    v_pk_add_f32 v[10:11], v[10:11], v[22:23]
    v_pk_fma_f32 v[14:15], v[22:23], v[22:23], v[14:15]
    s_waitcnt vmcnt(0)
    v_lshlrev_b32 v16, 16, v144
    v_and_b32 v17, s40, v144
    v_lshlrev_b32 v18, 16, v145
    v_and_b32 v19, s40, v145
    v_lshlrev_b32 v20, 16, v146
    v_and_b32 v21, s40, v146
    v_lshlrev_b32 v22, 16, v147
    v_and_b32 v23, s40, v147
    v_pk_add_f32 v[16:17], v[16:17], s[46:47] op_sel_hi:[1,0] neg_lo:[0,1] neg_hi:[0,1]
    v_pk_add_f32 v[18:19], v[18:19], s[46:47] op_sel_hi:[1,0] neg_lo:[0,1] neg_hi:[0,1]
    v_pk_add_f32 v[20:21], v[20:21], s[46:47] op_sel_hi:[1,0] neg_lo:[0,1] neg_hi:[0,1]
    v_pk_add_f32 v[22:23], v[22:23], s[46:47] op_sel_hi:[1,0] neg_lo:[0,1] neg_hi:[0,1]
    v_pk_add_f32 v[8:9], v[8:9], v[16:17]
    v_pk_fma_f32 v[12:13], v[16:17], v[16:17], v[12:13]
    v_pk_add_f32 v[10:11], v[10:11], v[18:19]
    v_pk_fma_f32 v[14:15], v[18:19], v[18:19], v[14:15]
    v_pk_add_f32 v[8:9], v[8:9], v[20:21]
    v_pk_fma_f32 v[12:13], v[20:21], v[20:21], v[12:13]
    v_pk_add_f32 v[10:11], v[10:11], v[22:23]
    v_pk_fma_f32 v[14:15], v[22:23], v[22:23], v[14:15]
L_post1:
    s_mov_b64 exec, -1
    v_pk_add_f32 v[8:9], v[8:9], v[10:11]
    v_pk_add_f32 v[12:13], v[12:13], v[14:15]
    s_nop 0
    v_add_f32 v8, v8, v9
    v_add_f32 v12, v12, v13
    s_nop 0
    v_add_f32_dpp v8, v8, v8 row_shr:1 row_mask:0xf bank_mask:0xf bound_ctrl:0
    v_add_f32_dpp v12, v12, v12 row_shr:1 row_mask:0xf bank_mask:0xf bound_ctrl:0
    s_nop 0
    v_add_f32_dpp v8, v8, v8 row_shr:2 row_mask:0xf bank_mask:0xf bound_ctrl:0
    v_add_f32_dpp v12, v12, v12 row_shr:2 row_mask:0xf bank_mask:0xf bound_ctrl:0
    s_nop 0
    v_add_f32_dpp v8, v8, v8 row_shr:4 row_mask:0xf bank_mask:0xf bound_ctrl:0
    v_add_f32_dpp v12, v12, v12 row_shr:4 row_mask:0xf bank_mask:0xf bound_ctrl:0
    s_nop 0
    v_add_f32_dpp v8, v8, v8 row_shr:8 row_mask:0xf bank_mask:0xf bound_ctrl:0
    v_add_f32_dpp v12, v12, v12 row_shr:8 row_mask:0xf bank_mask:0xf bound_ctrl:0
    s_nop 0
    v_add_f32_dpp v8, v8, v8 row_bcast:15 row_mask:0xa bank_mask:0xf
    v_add_f32_dpp v12, v12, v12 row_bcast:15 row_mask:0xa bank_mask:0xf
    s_nop 0
    v_add_f32_dpp v8, v8, v8 row_bcast:31 row_mask:0xc bank_mask:0xf
    v_add_f32_dpp v12, v12, v12 row_bcast:31 row_mask:0xc bank_mask:0xf
    v_mul_f32 v9, s43, v8
    s_mov_b32 exec_lo, 0
    s_mov_b32 exec_hi, 0x80000000
    v_fma_f32 v11, -v9, v8, v12
    v_add_f32 v10, s46, v9
    ds_write_b64 v4, v[10:11] offset:64
    ds_add_u32 v5, v6 offset:260
    s_mov_b64 exec, -1
L_flag0:
    ds_read_b32 v7, v5 offset:272
    ds_read_b64 v[2:3], v0 offset:512
    s_waitcnt lgkmcnt(0)
    v_readfirstlane_b32 s3, v7
    s_cmp_lg_u32 s3, 0
    s_cbranch_scc1 L_flagok0
    s_sleep 1
    s_branch L_flag0
L_flagok0:
    v_readlane_b32 s48, v2, 0
    v_readlane_b32 s49, v3, 0
    v_lshlrev_b32 v16, 16, v32
    v_and_b32 v17, s40, v32
    v_lshlrev_b32 v18, 16, v33
    v_and_b32 v19, s40, v33
    v_lshlrev_b32 v20, 16, v34
    v_and_b32 v21, s40, v34
    v_lshlrev_b32 v22, 16, v35
    v_and_b32 v23, s40, v35
    v_pk_fma_f32 v[16:17], v[16:17], s[48:49], s[48:49] op_sel:[0,0,1] op_sel_hi:[1,0,1]
    v_pk_fma_f32 v[18:19], v[18:19], s[48:49], s[48:49] op_sel:[0,0,1] op_sel_hi:[1,0,1]
    v_pk_fma_f32 v[20:21], v[20:21], s[48:49], s[48:49] op_sel:[0,0,1] op_sel_hi:[1,0,1]
    v_pk_fma_f32 v[22:23], v[22:23], s[48:49], s[48:49] op_sel:[0,0,1] op_sel_hi:[1,0,1]
    v_cvt_pk_bf16_f32 v32, v16, v17
    v_cvt_pk_bf16_f32 v33, v18, v19
    v_cvt_pk_bf16_f32 v34, v20, v21
    v_cvt_pk_bf16_f32 v35, v22, v23
    buffer_store_dwordx4 v[32:35], v1, s[20:23], 0 offen sc0 sc1
    v_readlane_b32 s50, v2, 1
    v_readlane_b32 s51, v3, 1
    v_lshlrev_b32 v24, 16, v36
    v_and_b32 v25, s40, v36
    v_lshlrev_b32 v26, 16, v37
    v_and_b32 v27, s40, v37
    v_lshlrev_b32 v28, 16, v38
    v_and_b32 v29, s40, v38
    v_lshlrev_b32 v30, 16, v39
    v_and_b32 v31, s40, v39
    v_pk_fma_f32 v[24:25], v[24:25], s[50:51], s[50:51] op_sel:[0,0,1] op_sel_hi:[1,0,1]
    v_pk_fma_f32 v[26:27], v[26:27], s[50:51], s[50:51] op_sel:[0,0,1] op_sel_hi:[1,0,1]
    v_pk_fma_f32 v[28:29], v[28:29], s[50:51], s[50:51] op_sel:[0,0,1] op_sel_hi:[1,0,1]
    v_pk_fma_f32 v[30:31], v[30:31], s[50:51], s[50:51] op_sel:[0,0,1] op_sel_hi:[1,0,1]
    v_cvt_pk_bf16_f32 v36, v24, v25
    v_cvt_pk_bf16_f32 v37, v26, v27
    v_cvt_pk_bf16_f32 v38, v28, v29
    v_cvt_pk_bf16_f32 v39, v30, v31
    s_mov_b32 s3, 131072
    buffer_store_dwordx4 v[36:39], v148, s[20:23], s3 offen sc0 sc1
    v_readlane_b32 s48, v2, 2
    v_readlane_b32 s49, v3, 2
    v_lshlrev_b32 v16, 16, v40
    v_and_b32 v17, s40, v40
    v_lshlrev_b32 v18, 16, v41
    v_and_b32 v19, s40, v41
    v_lshlrev_b32 v20, 16, v42
    v_and_b32 v21, s40, v42
    v_lshlrev_b32 v22, 16, v43
    v_and_b32 v23, s40, v43
    v_pk_fma_f32 v[16:17], v[16:17], s[48:49], s[48:49] op_sel:[0,0,1] op_sel_hi:[1,0,1]
    v_pk_fma_f32 v[18:19], v[18:19], s[48:49], s[48:49] op_sel:[0,0,1] op_sel_hi:[1,0,1]
    v_pk_fma_f32 v[20:21], v[20:21], s[48:49], s[48:49] op_sel:[0,0,1] op_sel_hi:[1,0,1]
    v_pk_fma_f32 v[22:23], v[22:23], s[48:49], s[48:49] op_sel:[0,0,1] op_sel_hi:[1,0,1]
    v_cvt_pk_bf16_f32 v40, v16, v17
    v_cvt_pk_bf16_f32 v41, v18, v19
    v_cvt_pk_bf16_f32 v42, v20, v21
    v_cvt_pk_bf16_f32 v43, v22, v23
    s_mov_b32 s3, 262144
    buffer_store_dwordx4 v[40:43], v1, s[20:23], s3 offen sc0 sc1
    v_readlane_b32 s50, v2, 3
    v_readlane_b32 s51, v3, 3
    v_lshlrev_b32 v24, 16, v44
    v_and_b32 v25, s40, v44
    v_lshlrev_b32 v26, 16, v45
    v_and_b32 v27, s40, v45
    v_lshlrev_b32 v28, 16, v46
    v_and_b32 v29, s40, v46
    v_lshlrev_b32 v30, 16, v47
    v_and_b32 v31, s40, v47
    v_pk_fma_f32 v[24:25], v[24:25], s[50:51], s[50:51] op_sel:[0,0,1] op_sel_hi:[1,0,1]
    v_pk_fma_f32 v[26:27], v[26:27], s[50:51], s[50:51] op_sel:[0,0,1] op_sel_hi:[1,0,1]
    v_pk_fma_f32 v[28:29], v[28:29], s[50:51], s[50:51] op_sel:[0,0,1] op_sel_hi:[1,0,1]
    v_pk_fma_f32 v[30:31], v[30:31], s[50:51], s[50:51] op_sel:[0,0,1] op_sel_hi:[1,0,1]
    v_cvt_pk_bf16_f32 v44, v24, v25
    v_cvt_pk_bf16_f32 v45, v26, v27
    v_cvt_pk_bf16_f32 v46, v28, v29
    v_cvt_pk_bf16_f32 v47, v30, v31
    s_mov_b32 s3, 393216
    buffer_store_dwordx4 v[44:47], v148, s[20:23], s3 offen sc0 sc1
    v_readlane_b32 s48, v2, 4
    v_readlane_b32 s49, v3, 4
    v_lshlrev_b32 v16, 16, v48
    v_and_b32 v17, s40, v48
    v_lshlrev_b32 v18, 16, v49
    v_and_b32 v19, s40, v49
    v_lshlrev_b32 v20, 16, v50
    v_and_b32 v21, s40, v50
    v_lshlrev_b32 v22, 16, v51
    v_and_b32 v23, s40, v51
    v_pk_fma_f32 v[16:17], v[16:17], s[48:49], s[48:49] op_sel:[0,0,1] op_sel_hi:[1,0,1]
    v_pk_fma_f32 v[18:19], v[18:19], s[48:49], s[48:49] op_sel:[0,0,1] op_sel_hi:[1,0,1]
    v_pk_fma_f32 v[20:21], v[20:21], s[48:49], s[48:49] op_sel:[0,0,1] op_sel_hi:[1,0,1]
    v_pk_fma_f32 v[22:23], v[22:23], s[48:49], s[48:49] op_sel:[0,0,1] op_sel_hi:[1,0,1]
    v_cvt_pk_bf16_f32 v48, v16, v17
    v_cvt_pk_bf16_f32 v49, v18, v19
    v_cvt_pk_bf16_f32 v50, v20, v21
    v_cvt_pk_bf16_f32 v51, v22, v23
    s_mov_b32 s3, 524288
    buffer_store_dwordx4 v[48:51], v1, s[20:23], s3 offen sc0 sc1
    v_readlane_b32 s50, v2, 5
    v_readlane_b32 s51, v3, 5
    v_lshlrev_b32 v24, 16, v52
    v_and_b32 v25, s40, v52
    v_lshlrev_b32 v26, 16, v53
    v_and_b32 v27, s40, v53
    v_lshlrev_b32 v28, 16, v54
    v_and_b32 v29, s40, v54
    v_lshlrev_b32 v30, 16, v55
    v_and_b32 v31, s40, v55
    v_pk_fma_f32 v[24:25], v[24:25], s[50:51], s[50:51] op_sel:[0,0,1] op_sel_hi:[1,0,1]
    v_pk_fma_f32 v[26:27], v[26:27], s[50:51], s[50:51] op_sel:[0,0,1] op_sel_hi:[1,0,1]
    v_pk_fma_f32 v[28:29], v[28:29], s[50:51], s[50:51] op_sel:[0,0,1] op_sel_hi:[1,0,1]
    v_pk_fma_f32 v[30:31], v[30:31], s[50:51], s[50:51] op_sel:[0,0,1] op_sel_hi:[1,0,1]
    v_cvt_pk_bf16_f32 v52, v24, v25
    v_cvt_pk_bf16_f32 v53, v26, v27
    v_cvt_pk_bf16_f32 v54, v28, v29
    v_cvt_pk_bf16_f32 v55, v30, v31
    s_mov_b32 s3, 655360
    buffer_store_dwordx4 v[52:55], v148, s[20:23], s3 offen sc0 sc1
    v_readlane_b32 s48, v2, 6
    v_readlane_b32 s49, v3, 6
    v_lshlrev_b32 v16, 16, v56
    v_and_b32 v17, s40, v56
    v_lshlrev_b32 v18, 16, v57
    v_and_b32 v19, s40, v57
    v_lshlrev_b32 v20, 16, v58
    v_and_b32 v21, s40, v58
    v_lshlrev_b32 v22, 16, v59
    v_and_b32 v23, s40, v59
    v_pk_fma_f32 v[16:17], v[16:17], s[48:49], s[48:49] op_sel:[0,0,1] op_sel_hi:[1,0,1]
    v_pk_fma_f32 v[18:19], v[18:19], s[48:49], s[48:49] op_sel:[0,0,1] op_sel_hi:[1,0,1]
    v_pk_fma_f32 v[20:21], v[20:21], s[48:49], s[48:49] op_sel:[0,0,1] op_sel_hi:[1,0,1]
    v_pk_fma_f32 v[22:23], v[22:23], s[48:49], s[48:49] op_sel:[0,0,1] op_sel_hi:[1,0,1]
    v_cvt_pk_bf16_f32 v56, v16, v17
    v_cvt_pk_bf16_f32 v57, v18, v19
    v_cvt_pk_bf16_f32 v58, v20, v21
    v_cvt_pk_bf16_f32 v59, v22, v23
    s_mov_b32 s3, 786432
    buffer_store_dwordx4 v[56:59], v1, s[20:23], s3 offen sc0 sc1
    v_readlane_b32 s50, v2, 7
    v_readlane_b32 s51, v3, 7
    v_lshlrev_b32 v24, 16, v60
    v_and_b32 v25, s40, v60
    v_lshlrev_b32 v26, 16, v61
    v_and_b32 v27, s40, v61
    v_lshlrev_b32 v28, 16, v62
    v_and_b32 v29, s40, v62
    v_lshlrev_b32 v30, 16, v63
    v_and_b32 v31, s40, v63
    v_pk_fma_f32 v[24:25], v[24:25], s[50:51], s[50:51] op_sel:[0,0,1] op_sel_hi:[1,0,1]
    v_pk_fma_f32 v[26:27], v[26:27], s[50:51], s[50:51] op_sel:[0,0,1] op_sel_hi:[1,0,1]
    v_pk_fma_f32 v[28:29], v[28:29], s[50:51], s[50:51] op_sel:[0,0,1] op_sel_hi:[1,0,1]
    v_pk_fma_f32 v[30:31], v[30:31], s[50:51], s[50:51] op_sel:[0,0,1] op_sel_hi:[1,0,1]
    v_cvt_pk_bf16_f32 v60, v24, v25
    v_cvt_pk_bf16_f32 v61, v26, v27
    v_cvt_pk_bf16_f32 v62, v28, v29
    v_cvt_pk_bf16_f32 v63, v30, v31
    s_mov_b32 s3, 917504
    buffer_store_dwordx4 v[60:63], v148, s[20:23], s3 offen sc0 sc1
    v_readlane_b32 s48, v2, 8
    v_readlane_b32 s49, v3, 8
    v_lshlrev_b32 v16, 16, v64
    v_and_b32 v17, s40, v64
    v_lshlrev_b32 v18, 16, v65
    v_and_b32 v19, s40, v65
    v_lshlrev_b32 v20, 16, v66
    v_and_b32 v21, s40, v66
    v_lshlrev_b32 v22, 16, v67
    v_and_b32 v23, s40, v67
    v_pk_fma_f32 v[16:17], v[16:17], s[48:49], s[48:49] op_sel:[0,0,1] op_sel_hi:[1,0,1]
    v_pk_fma_f32 v[18:19], v[18:19], s[48:49], s[48:49] op_sel:[0,0,1] op_sel_hi:[1,0,1]
    v_pk_fma_f32 v[20:21], v[20:21], s[48:49], s[48:49] op_sel:[0,0,1] op_sel_hi:[1,0,1]
    v_pk_fma_f32 v[22:23], v[22:23], s[48:49], s[48:49] op_sel:[0,0,1] op_sel_hi:[1,0,1]
    v_cvt_pk_bf16_f32 v64, v16, v17
    v_cvt_pk_bf16_f32 v65, v18, v19
    v_cvt_pk_bf16_f32 v66, v20, v21
    v_cvt_pk_bf16_f32 v67, v22, v23
    s_mov_b32 s3, 1048576
    buffer_store_dwordx4 v[64:67], v1, s[20:23], s3 offen sc0 sc1
    v_readlane_b32 s50, v2, 9
    v_readlane_b32 s51, v3, 9
    v_lshlrev_b32 v24, 16, v68
    v_and_b32 v25, s40, v68
    v_lshlrev_b32 v26, 16, v69
    v_and_b32 v27, s40, v69
    v_lshlrev_b32 v28, 16, v70
    v_and_b32 v29, s40, v70
    v_lshlrev_b32 v30, 16, v71
    v_and_b32 v31, s40, v71
    v_pk_fma_f32 v[24:25], v[24:25], s[50:51], s[50:51] op_sel:[0,0,1] op_sel_hi:[1,0,1]
    v_pk_fma_f32 v[26:27], v[26:27], s[50:51], s[50:51] op_sel:[0,0,1] op_sel_hi:[1,0,1]
    v_pk_fma_f32 v[28:29], v[28:29], s[50:51], s[50:51] op_sel:[0,0,1] op_sel_hi:[1,0,1]
    v_pk_fma_f32 v[30:31], v[30:31], s[50:51], s[50:51] op_sel:[0,0,1] op_sel_hi:[1,0,1]
    v_cvt_pk_bf16_f32 v68, v24, v25
    v_cvt_pk_bf16_f32 v69, v26, v27
    v_cvt_pk_bf16_f32 v70, v28, v29
    v_cvt_pk_bf16_f32 v71, v30, v31
    s_mov_b32 s3, 1179648
    buffer_store_dwordx4 v[68:71], v148, s[20:23], s3 offen sc0 sc1
    v_readlane_b32 s48, v2, 10
    v_readlane_b32 s49, v3, 10
    v_lshlrev_b32 v16, 16, v72
    v_and_b32 v17, s40, v72
    v_lshlrev_b32 v18, 16, v73
    v_and_b32 v19, s40, v73
    v_lshlrev_b32 v20, 16, v74
    v_and_b32 v21, s40, v74
    v_lshlrev_b32 v22, 16, v75
    v_and_b32 v23, s40, v75
    v_pk_fma_f32 v[16:17], v[16:17], s[48:49], s[48:49] op_sel:[0,0,1] op_sel_hi:[1,0,1]
    v_pk_fma_f32 v[18:19], v[18:19], s[48:49], s[48:49] op_sel:[0,0,1] op_sel_hi:[1,0,1]
    v_pk_fma_f32 v[20:21], v[20:21], s[48:49], s[48:49] op_sel:[0,0,1] op_sel_hi:[1,0,1]
    v_pk_fma_f32 v[22:23], v[22:23], s[48:49], s[48:49] op_sel:[0,0,1] op_sel_hi:[1,0,1]
    v_cvt_pk_bf16_f32 v72, v16, v17
    v_cvt_pk_bf16_f32 v73, v18, v19
    v_cvt_pk_bf16_f32 v74, v20, v21
    v_cvt_pk_bf16_f32 v75, v22, v23
    s_mov_b32 s3, 1310720
    buffer_store_dwordx4 v[72:75], v1, s[20:23], s3 offen sc0 sc1
    v_readlane_b32 s50, v2, 11
    v_readlane_b32 s51, v3, 11
    v_lshlrev_b32 v24, 16, v76
    v_and_b32 v25, s40, v76
    v_lshlrev_b32 v26, 16, v77
    v_and_b32 v27, s40, v77
    v_lshlrev_b32 v28, 16, v78
    v_and_b32 v29, s40, v78
    v_lshlrev_b32 v30, 16, v79
    v_and_b32 v31, s40, v79
    v_pk_fma_f32 v[24:25], v[24:25], s[50:51], s[50:51] op_sel:[0,0,1] op_sel_hi:[1,0,1]
    v_pk_fma_f32 v[26:27], v[26:27], s[50:51], s[50:51] op_sel:[0,0,1] op_sel_hi:[1,0,1]
    v_pk_fma_f32 v[28:29], v[28:29], s[50:51], s[50:51] op_sel:[0,0,1] op_sel_hi:[1,0,1]
    v_pk_fma_f32 v[30:31], v[30:31], s[50:51], s[50:51] op_sel:[0,0,1] op_sel_hi:[1,0,1]
    v_cvt_pk_bf16_f32 v76, v24, v25
    v_cvt_pk_bf16_f32 v77, v26, v27
    v_cvt_pk_bf16_f32 v78, v28, v29
    v_cvt_pk_bf16_f32 v79, v30, v31
    s_mov_b32 s3, 1441792
    buffer_store_dwordx4 v[76:79], v148, s[20:23], s3 offen sc0 sc1
    v_readlane_b32 s48, v2, 12
    v_readlane_b32 s49, v3, 12
    v_lshlrev_b32 v16, 16, v80
    v_and_b32 v17, s40, v80
    v_lshlrev_b32 v18, 16, v81
    v_and_b32 v19, s40, v81
    v_lshlrev_b32 v20, 16, v82
    v_and_b32 v21, s40, v82
    v_lshlrev_b32 v22, 16, v83
    v_and_b32 v23, s40, v83
    v_pk_fma_f32 v[16:17], v[16:17], s[48:49], s[48:49] op_sel:[0,0,1] op_sel_hi:[1,0,1]
    v_pk_fma_f32 v[18:19], v[18:19], s[48:49], s[48:49] op_sel:[0,0,1] op_sel_hi:[1,0,1]
    v_pk_fma_f32 v[20:21], v[20:21], s[48:49], s[48:49] op_sel:[0,0,1] op_sel_hi:[1,0,1]
    v_pk_fma_f32 v[22:23], v[22:23], s[48:49], s[48:49] op_sel:[0,0,1] op_sel_hi:[1,0,1]
    v_cvt_pk_bf16_f32 v80, v16, v17
    v_cvt_pk_bf16_f32 v81, v18, v19
    v_cvt_pk_bf16_f32 v82, v20, v21
    v_cvt_pk_bf16_f32 v83, v22, v23
    s_mov_b32 s3, 1572864
    buffer_store_dwordx4 v[80:83], v1, s[20:23], s3 offen sc0 sc1
    v_readlane_b32 s50, v2, 13
    v_readlane_b32 s51, v3, 13
    v_lshlrev_b32 v24, 16, v84
    v_and_b32 v25, s40, v84
    v_lshlrev_b32 v26, 16, v85
    v_and_b32 v27, s40, v85
    v_lshlrev_b32 v28, 16, v86
    v_and_b32 v29, s40, v86
    v_lshlrev_b32 v30, 16, v87
    v_and_b32 v31, s40, v87
    v_pk_fma_f32 v[24:25], v[24:25], s[50:51], s[50:51] op_sel:[0,0,1] op_sel_hi:[1,0,1]
    v_pk_fma_f32 v[26:27], v[26:27], s[50:51], s[50:51] op_sel:[0,0,1] op_sel_hi:[1,0,1]
    v_pk_fma_f32 v[28:29], v[28:29], s[50:51], s[50:51] op_sel:[0,0,1] op_sel_hi:[1,0,1]
    v_pk_fma_f32 v[30:31], v[30:31], s[50:51], s[50:51] op_sel:[0,0,1] op_sel_hi:[1,0,1]
    v_cvt_pk_bf16_f32 v84, v24, v25
    v_cvt_pk_bf16_f32 v85, v26, v27
    v_cvt_pk_bf16_f32 v86, v28, v29
    v_cvt_pk_bf16_f32 v87, v30, v31
    s_mov_b32 s3, 1703936
    buffer_store_dwordx4 v[84:87], v148, s[20:23], s3 offen sc0 sc1
L_flag1:
    ds_read_b32 v7, v5 offset:276
    ds_read_b64 v[2:3], v0 offset:640
    s_waitcnt lgkmcnt(0)
    v_readfirstlane_b32 s3, v7
    s_cmp_lg_u32 s3, 0
    s_cbranch_scc1 L_flagok1
    s_sleep 1
    s_branch L_flag1
L_flagok1:
    v_readlane_b32 s48, v2, 0
    v_readlane_b32 s49, v3, 0
    v_lshlrev_b32 v16, 16, v88
    v_and_b32 v17, s40, v88
    v_lshlrev_b32 v18, 16, v89
    v_and_b32 v19, s40, v89
    v_lshlrev_b32 v20, 16, v90
    v_and_b32 v21, s40, v90
    v_lshlrev_b32 v22, 16, v91
    v_and_b32 v23, s40, v91
    v_pk_fma_f32 v[16:17], v[16:17], s[48:49], s[48:49] op_sel:[0,0,1] op_sel_hi:[1,0,1]
    v_pk_fma_f32 v[18:19], v[18:19], s[48:49], s[48:49] op_sel:[0,0,1] op_sel_hi:[1,0,1]
    v_pk_fma_f32 v[20:21], v[20:21], s[48:49], s[48:49] op_sel:[0,0,1] op_sel_hi:[1,0,1]
    v_pk_fma_f32 v[22:23], v[22:23], s[48:49], s[48:49] op_sel:[0,0,1] op_sel_hi:[1,0,1]
    v_cvt_pk_bf16_f32 v88, v16, v17
    v_cvt_pk_bf16_f32 v89, v18, v19
    v_cvt_pk_bf16_f32 v90, v20, v21
    v_cvt_pk_bf16_f32 v91, v22, v23
    s_mov_b32 s3, 29360128
    buffer_store_dwordx4 v[88:91], v1, s[20:23], s3 offen sc0 sc1
    v_readlane_b32 s50, v2, 1
    v_readlane_b32 s51, v3, 1
    v_lshlrev_b32 v24, 16, v92
    v_and_b32 v25, s40, v92
    v_lshlrev_b32 v26, 16, v93
    v_and_b32 v27, s40, v93
    v_lshlrev_b32 v28, 16, v94
    v_and_b32 v29, s40, v94
    v_lshlrev_b32 v30, 16, v95
    v_and_b32 v31, s40, v95
    v_pk_fma_f32 v[24:25], v[24:25], s[50:51], s[50:51] op_sel:[0,0,1] op_sel_hi:[1,0,1]
    v_pk_fma_f32 v[26:27], v[26:27], s[50:51], s[50:51] op_sel:[0,0,1] op_sel_hi:[1,0,1]
    v_pk_fma_f32 v[28:29], v[28:29], s[50:51], s[50:51] op_sel:[0,0,1] op_sel_hi:[1,0,1]
    v_pk_fma_f32 v[30:31], v[30:31], s[50:51], s[50:51] op_sel:[0,0,1] op_sel_hi:[1,0,1]
    v_cvt_pk_bf16_f32 v92, v24, v25
    v_cvt_pk_bf16_f32 v93, v26, v27
    v_cvt_pk_bf16_f32 v94, v28, v29
    v_cvt_pk_bf16_f32 v95, v30, v31
    s_mov_b32 s3, 29491200
    buffer_store_dwordx4 v[92:95], v148, s[20:23], s3 offen sc0 sc1
    v_readlane_b32 s48, v2, 2
    v_readlane_b32 s49, v3, 2
    v_lshlrev_b32 v16, 16, v96
    v_and_b32 v17, s40, v96
    v_lshlrev_b32 v18, 16, v97
    v_and_b32 v19, s40, v97
    v_lshlrev_b32 v20, 16, v98
    v_and_b32 v21, s40, v98
    v_lshlrev_b32 v22, 16, v99
    v_and_b32 v23, s40, v99
    v_pk_fma_f32 v[16:17], v[16:17], s[48:49], s[48:49] op_sel:[0,0,1] op_sel_hi:[1,0,1]
    v_pk_fma_f32 v[18:19], v[18:19], s[48:49], s[48:49] op_sel:[0,0,1] op_sel_hi:[1,0,1]
    v_pk_fma_f32 v[20:21], v[20:21], s[48:49], s[48:49] op_sel:[0,0,1] op_sel_hi:[1,0,1]
    v_pk_fma_f32 v[22:23], v[22:23], s[48:49], s[48:49] op_sel:[0,0,1] op_sel_hi:[1,0,1]
    v_cvt_pk_bf16_f32 v96, v16, v17
    v_cvt_pk_bf16_f32 v97, v18, v19
    v_cvt_pk_bf16_f32 v98, v20, v21
    v_cvt_pk_bf16_f32 v99, v22, v23
    s_mov_b32 s3, 29622272
    buffer_store_dwordx4 v[96:99], v1, s[20:23], s3 offen sc0 sc1
    v_readlane_b32 s50, v2, 3
    v_readlane_b32 s51, v3, 3
    v_lshlrev_b32 v24, 16, v100
    v_and_b32 v25, s40, v100
    v_lshlrev_b32 v26, 16, v101
    v_and_b32 v27, s40, v101
    v_lshlrev_b32 v28, 16, v102
    v_and_b32 v29, s40, v102
    v_lshlrev_b32 v30, 16, v103
    v_and_b32 v31, s40, v103
    v_pk_fma_f32 v[24:25], v[24:25], s[50:51], s[50:51] op_sel:[0,0,1] op_sel_hi:[1,0,1]
    v_pk_fma_f32 v[26:27], v[26:27], s[50:51], s[50:51] op_sel:[0,0,1] op_sel_hi:[1,0,1]
    v_pk_fma_f32 v[28:29], v[28:29], s[50:51], s[50:51] op_sel:[0,0,1] op_sel_hi:[1,0,1]
    v_pk_fma_f32 v[30:31], v[30:31], s[50:51], s[50:51] op_sel:[0,0,1] op_sel_hi:[1,0,1]
    v_cvt_pk_bf16_f32 v100, v24, v25
    v_cvt_pk_bf16_f32 v101, v26, v27
    v_cvt_pk_bf16_f32 v102, v28, v29
    v_cvt_pk_bf16_f32 v103, v30, v31
    s_mov_b32 s3, 29753344
    buffer_store_dwordx4 v[100:103], v148, s[20:23], s3 offen sc0 sc1
    v_readlane_b32 s48, v2, 4
    v_readlane_b32 s49, v3, 4
    v_lshlrev_b32 v16, 16, v104
    v_and_b32 v17, s40, v104
    v_lshlrev_b32 v18, 16, v105
    v_and_b32 v19, s40, v105
    v_lshlrev_b32 v20, 16, v106
    v_and_b32 v21, s40, v106
    v_lshlrev_b32 v22, 16, v107
    v_and_b32 v23, s40, v107
    v_pk_fma_f32 v[16:17], v[16:17], s[48:49], s[48:49] op_sel:[0,0,1] op_sel_hi:[1,0,1]
    v_pk_fma_f32 v[18:19], v[18:19], s[48:49], s[48:49] op_sel:[0,0,1] op_sel_hi:[1,0,1]
    v_pk_fma_f32 v[20:21], v[20:21], s[48:49], s[48:49] op_sel:[0,0,1] op_sel_hi:[1,0,1]
    v_pk_fma_f32 v[22:23], v[22:23], s[48:49], s[48:49] op_sel:[0,0,1] op_sel_hi:[1,0,1]
    v_cvt_pk_bf16_f32 v104, v16, v17
    v_cvt_pk_bf16_f32 v105, v18, v19
    v_cvt_pk_bf16_f32 v106, v20, v21
    v_cvt_pk_bf16_f32 v107, v22, v23
    s_mov_b32 s3, 29884416
    buffer_store_dwordx4 v[104:107], v1, s[20:23], s3 offen sc0 sc1
    v_readlane_b32 s50, v2, 5
    v_readlane_b32 s51, v3, 5
    v_lshlrev_b32 v24, 16, v108
    v_and_b32 v25, s40, v108
    v_lshlrev_b32 v26, 16, v109
    v_and_b32 v27, s40, v109
    v_lshlrev_b32 v28, 16, v110
    v_and_b32 v29, s40, v110
    v_lshlrev_b32 v30, 16, v111
    v_and_b32 v31, s40, v111
    v_pk_fma_f32 v[24:25], v[24:25], s[50:51], s[50:51] op_sel:[0,0,1] op_sel_hi:[1,0,1]
    v_pk_fma_f32 v[26:27], v[26:27], s[50:51], s[50:51] op_sel:[0,0,1] op_sel_hi:[1,0,1]
    v_pk_fma_f32 v[28:29], v[28:29], s[50:51], s[50:51] op_sel:[0,0,1] op_sel_hi:[1,0,1]
    v_pk_fma_f32 v[30:31], v[30:31], s[50:51], s[50:51] op_sel:[0,0,1] op_sel_hi:[1,0,1]
    v_cvt_pk_bf16_f32 v108, v24, v25
    v_cvt_pk_bf16_f32 v109, v26, v27
    v_cvt_pk_bf16_f32 v110, v28, v29
    v_cvt_pk_bf16_f32 v111, v30, v31
    s_mov_b32 s3, 30015488
    buffer_store_dwordx4 v[108:111], v148, s[20:23], s3 offen sc0 sc1
    v_readlane_b32 s48, v2, 6
    v_readlane_b32 s49, v3, 6
    v_lshlrev_b32 v16, 16, v112
    v_and_b32 v17, s40, v112
    v_lshlrev_b32 v18, 16, v113
    v_and_b32 v19, s40, v113
    v_lshlrev_b32 v20, 16, v114
    v_and_b32 v21, s40, v114
    v_lshlrev_b32 v22, 16, v115
    v_and_b32 v23, s40, v115
    v_pk_fma_f32 v[16:17], v[16:17], s[48:49], s[48:49] op_sel:[0,0,1] op_sel_hi:[1,0,1]
    v_pk_fma_f32 v[18:19], v[18:19], s[48:49], s[48:49] op_sel:[0,0,1] op_sel_hi:[1,0,1]
    v_pk_fma_f32 v[20:21], v[20:21], s[48:49], s[48:49] op_sel:[0,0,1] op_sel_hi:[1,0,1]
    v_pk_fma_f32 v[22:23], v[22:23], s[48:49], s[48:49] op_sel:[0,0,1] op_sel_hi:[1,0,1]
    v_cvt_pk_bf16_f32 v112, v16, v17
    v_cvt_pk_bf16_f32 v113, v18, v19
    v_cvt_pk_bf16_f32 v114, v20, v21
    v_cvt_pk_bf16_f32 v115, v22, v23
    s_mov_b32 s3, 30146560
    buffer_store_dwordx4 v[112:115], v1, s[20:23], s3 offen sc0 sc1
    v_readlane_b32 s50, v2, 7
    v_readlane_b32 s51, v3, 7
    v_lshlrev_b32 v24, 16, v116
    v_and_b32 v25, s40, v116
    v_lshlrev_b32 v26, 16, v117
    v_and_b32 v27, s40, v117
    v_lshlrev_b32 v28, 16, v118
    v_and_b32 v29, s40, v118
    v_lshlrev_b32 v30, 16, v119
    v_and_b32 v31, s40, v119
    v_pk_fma_f32 v[24:25], v[24:25], s[50:51], s[50:51] op_sel:[0,0,1] op_sel_hi:[1,0,1]
    v_pk_fma_f32 v[26:27], v[26:27], s[50:51], s[50:51] op_sel:[0,0,1] op_sel_hi:[1,0,1]
    v_pk_fma_f32 v[28:29], v[28:29], s[50:51], s[50:51] op_sel:[0,0,1] op_sel_hi:[1,0,1]
    v_pk_fma_f32 v[30:31], v[30:31], s[50:51], s[50:51] op_sel:[0,0,1] op_sel_hi:[1,0,1]
    v_cvt_pk_bf16_f32 v116, v24, v25
    v_cvt_pk_bf16_f32 v117, v26, v27
    v_cvt_pk_bf16_f32 v118, v28, v29
    v_cvt_pk_bf16_f32 v119, v30, v31
    s_mov_b32 s3, 30277632
    buffer_store_dwordx4 v[116:119], v148, s[20:23], s3 offen sc0 sc1
    v_readlane_b32 s48, v2, 8
    v_readlane_b32 s49, v3, 8
    v_lshlrev_b32 v16, 16, v120
    v_and_b32 v17, s40, v120
    v_lshlrev_b32 v18, 16, v121
    v_and_b32 v19, s40, v121
    v_lshlrev_b32 v20, 16, v122
    v_and_b32 v21, s40, v122
    v_lshlrev_b32 v22, 16, v123
    v_and_b32 v23, s40, v123
    v_pk_fma_f32 v[16:17], v[16:17], s[48:49], s[48:49] op_sel:[0,0,1] op_sel_hi:[1,0,1]
    v_pk_fma_f32 v[18:19], v[18:19], s[48:49], s[48:49] op_sel:[0,0,1] op_sel_hi:[1,0,1]
    v_pk_fma_f32 v[20:21], v[20:21], s[48:49], s[48:49] op_sel:[0,0,1] op_sel_hi:[1,0,1]
    v_pk_fma_f32 v[22:23], v[22:23], s[48:49], s[48:49] op_sel:[0,0,1] op_sel_hi:[1,0,1]
    v_cvt_pk_bf16_f32 v120, v16, v17
    v_cvt_pk_bf16_f32 v121, v18, v19
    v_cvt_pk_bf16_f32 v122, v20, v21
    v_cvt_pk_bf16_f32 v123, v22, v23
    s_mov_b32 s3, 30408704
    buffer_store_dwordx4 v[120:123], v1, s[20:23], s3 offen sc0 sc1
    v_readlane_b32 s50, v2, 9
    v_readlane_b32 s51, v3, 9
    v_lshlrev_b32 v24, 16, v124
    v_and_b32 v25, s40, v124
    v_lshlrev_b32 v26, 16, v125
    v_and_b32 v27, s40, v125
    v_lshlrev_b32 v28, 16, v126
    v_and_b32 v29, s40, v126
    v_lshlrev_b32 v30, 16, v127
    v_and_b32 v31, s40, v127
    v_pk_fma_f32 v[24:25], v[24:25], s[50:51], s[50:51] op_sel:[0,0,1] op_sel_hi:[1,0,1]
    v_pk_fma_f32 v[26:27], v[26:27], s[50:51], s[50:51] op_sel:[0,0,1] op_sel_hi:[1,0,1]
    v_pk_fma_f32 v[28:29], v[28:29], s[50:51], s[50:51] op_sel:[0,0,1] op_sel_hi:[1,0,1]
    v_pk_fma_f32 v[30:31], v[30:31], s[50:51], s[50:51] op_sel:[0,0,1] op_sel_hi:[1,0,1]
    v_cvt_pk_bf16_f32 v124, v24, v25
    v_cvt_pk_bf16_f32 v125, v26, v27
    v_cvt_pk_bf16_f32 v126, v28, v29
    v_cvt_pk_bf16_f32 v127, v30, v31
    s_mov_b32 s3, 30539776
    buffer_store_dwordx4 v[124:127], v148, s[20:23], s3 offen sc0 sc1
    v_readlane_b32 s48, v2, 10
    v_readlane_b32 s49, v3, 10
    v_lshlrev_b32 v16, 16, v128
    v_and_b32 v17, s40, v128
    v_lshlrev_b32 v18, 16, v129
    v_and_b32 v19, s40, v129
    v_lshlrev_b32 v20, 16, v130
    v_and_b32 v21, s40, v130
    v_lshlrev_b32 v22, 16, v131
    v_and_b32 v23, s40, v131
    v_pk_fma_f32 v[16:17], v[16:17], s[48:49], s[48:49] op_sel:[0,0,1] op_sel_hi:[1,0,1]
    v_pk_fma_f32 v[18:19], v[18:19], s[48:49], s[48:49] op_sel:[0,0,1] op_sel_hi:[1,0,1]
    v_pk_fma_f32 v[20:21], v[20:21], s[48:49], s[48:49] op_sel:[0,0,1] op_sel_hi:[1,0,1]
    v_pk_fma_f32 v[22:23], v[22:23], s[48:49], s[48:49] op_sel:[0,0,1] op_sel_hi:[1,0,1]
    v_cvt_pk_bf16_f32 v128, v16, v17
    v_cvt_pk_bf16_f32 v129, v18, v19
    v_cvt_pk_bf16_f32 v130, v20, v21
    v_cvt_pk_bf16_f32 v131, v22, v23
    s_mov_b32 s3, 30670848
    buffer_store_dwordx4 v[128:131], v1, s[20:23], s3 offen sc0 sc1
    v_readlane_b32 s50, v2, 11
    v_readlane_b32 s51, v3, 11
    v_lshlrev_b32 v24, 16, v132
    v_and_b32 v25, s40, v132
    v_lshlrev_b32 v26, 16, v133
    v_and_b32 v27, s40, v133
    v_lshlrev_b32 v28, 16, v134
    v_and_b32 v29, s40, v134
    v_lshlrev_b32 v30, 16, v135
    v_and_b32 v31, s40, v135
    v_pk_fma_f32 v[24:25], v[24:25], s[50:51], s[50:51] op_sel:[0,0,1] op_sel_hi:[1,0,1]
    v_pk_fma_f32 v[26:27], v[26:27], s[50:51], s[50:51] op_sel:[0,0,1] op_sel_hi:[1,0,1]
    v_pk_fma_f32 v[28:29], v[28:29], s[50:51], s[50:51] op_sel:[0,0,1] op_sel_hi:[1,0,1]
    v_pk_fma_f32 v[30:31], v[30:31], s[50:51], s[50:51] op_sel:[0,0,1] op_sel_hi:[1,0,1]
    v_cvt_pk_bf16_f32 v132, v24, v25
    v_cvt_pk_bf16_f32 v133, v26, v27
    v_cvt_pk_bf16_f32 v134, v28, v29
    v_cvt_pk_bf16_f32 v135, v30, v31
    s_mov_b32 s3, 30801920
    buffer_store_dwordx4 v[132:135], v148, s[20:23], s3 offen sc0 sc1
    v_readlane_b32 s48, v2, 12
    v_readlane_b32 s49, v3, 12
    v_lshlrev_b32 v16, 16, v136
    v_and_b32 v17, s40, v136
    v_lshlrev_b32 v18, 16, v137
    v_and_b32 v19, s40, v137
    v_lshlrev_b32 v20, 16, v138
    v_and_b32 v21, s40, v138
    v_lshlrev_b32 v22, 16, v139
    v_and_b32 v23, s40, v139
    v_pk_fma_f32 v[16:17], v[16:17], s[48:49], s[48:49] op_sel:[0,0,1] op_sel_hi:[1,0,1]
    v_pk_fma_f32 v[18:19], v[18:19], s[48:49], s[48:49] op_sel:[0,0,1] op_sel_hi:[1,0,1]
    v_pk_fma_f32 v[20:21], v[20:21], s[48:49], s[48:49] op_sel:[0,0,1] op_sel_hi:[1,0,1]
    v_pk_fma_f32 v[22:23], v[22:23], s[48:49], s[48:49] op_sel:[0,0,1] op_sel_hi:[1,0,1]
    v_cvt_pk_bf16_f32 v136, v16, v17
    v_cvt_pk_bf16_f32 v137, v18, v19
    v_cvt_pk_bf16_f32 v138, v20, v21
    v_cvt_pk_bf16_f32 v139, v22, v23
    s_mov_b32 s3, 30932992
    buffer_store_dwordx4 v[136:139], v1, s[20:23], s3 offen sc0 sc1
    s_bitcmp1_b32 s38, 0
    s_cbranch_scc0 L_rest
    s_endpgm
L_rest:
    v_readlane_b32 s50, v2, 13
    v_readlane_b32 s51, v3, 13
    v_lshlrev_b32 v24, 16, v140
    v_and_b32 v25, s40, v140
    v_lshlrev_b32 v26, 16, v141
    v_and_b32 v27, s40, v141
    v_lshlrev_b32 v28, 16, v142
    v_and_b32 v29, s40, v142
    v_lshlrev_b32 v30, 16, v143
    v_and_b32 v31, s40, v143
    v_pk_fma_f32 v[24:25], v[24:25], s[50:51], s[50:51] op_sel:[0,0,1] op_sel_hi:[1,0,1]
    v_pk_fma_f32 v[26:27], v[26:27], s[50:51], s[50:51] op_sel:[0,0,1] op_sel_hi:[1,0,1]
    v_pk_fma_f32 v[28:29], v[28:29], s[50:51], s[50:51] op_sel:[0,0,1] op_sel_hi:[1,0,1]
    v_pk_fma_f32 v[30:31], v[30:31], s[50:51], s[50:51] op_sel:[0,0,1] op_sel_hi:[1,0,1]
    v_cvt_pk_bf16_f32 v140, v24, v25
    v_cvt_pk_bf16_f32 v141, v26, v27
    v_cvt_pk_bf16_f32 v142, v28, v29
    v_cvt_pk_bf16_f32 v143, v30, v31
    s_mov_b32 s3, 31064064
    buffer_store_dwordx4 v[140:143], v1, s[20:23], s3 offen sc0 sc1
    v_readlane_b32 s48, v2, 13
    v_readlane_b32 s49, v3, 13
    v_lshlrev_b32 v16, 16, v144
    v_and_b32 v17, s40, v144
    v_lshlrev_b32 v18, 16, v145
    v_and_b32 v19, s40, v145
    v_lshlrev_b32 v20, 16, v146
    v_and_b32 v21, s40, v146
    v_lshlrev_b32 v22, 16, v147
    v_and_b32 v23, s40, v147
    v_pk_fma_f32 v[16:17], v[16:17], s[48:49], s[48:49] op_sel:[0,0,1] op_sel_hi:[1,0,1]
    v_pk_fma_f32 v[18:19], v[18:19], s[48:49], s[48:49] op_sel:[0,0,1] op_sel_hi:[1,0,1]
    v_pk_fma_f32 v[20:21], v[20:21], s[48:49], s[48:49] op_sel:[0,0,1] op_sel_hi:[1,0,1]
    v_pk_fma_f32 v[22:23], v[22:23], s[48:49], s[48:49] op_sel:[0,0,1] op_sel_hi:[1,0,1]
    v_cvt_pk_bf16_f32 v144, v16, v17
    v_cvt_pk_bf16_f32 v145, v18, v19
    v_cvt_pk_bf16_f32 v146, v20, v21
    v_cvt_pk_bf16_f32 v147, v22, v23
    s_mov_b32 s3, 31064064
    buffer_store_dwordx4 v[144:147], v148, s[20:23], s3 offen sc0 sc1
L_data_end:
    s_endpgm
L_service:
    s_load_dwordx4 s[4:7], s[0:1], 8
    s_load_dwordx2 s[12:13], s[0:1], 40
    s_setprio 3
    v_and_b32 v0, 63, v0
    s_mov_b32 s30, 896
    s_mov_b32 s31, 0x20000
    s_mov_b32 s34, 896
    s_mov_b32 s35, 0x20000
    s_mul_i32 s3, s41, 768
    s_add_u32 s14, s3, 512
    s_lshl_b32 s15, s38, 4
    s_waitcnt lgkmcnt(0)
    s_load_dwordx2 s[20:21], s[12:13], s14 glc
    s_mov_b32 s28, s4
    s_mov_b32 s29, s5
    s_mov_b32 s32, s6
    s_mov_b32 s33, s7
    s_mul_i32 s22, s41, 28
    s_add_u32 s23, s22, 448
    s_buffer_load_dwordx8 s[44:51], s[28:31], s22
    s_buffer_load_dwordx8 s[52:59], s[32:35], s22
    s_buffer_load_dwordx8 s[60:67], s[28:31], s23
    s_buffer_load_dwordx8 s[68:75], s[32:35], s23
    v_lshlrev_b32 v1, 3, v0
    s_add_u32 s26, s12, s3
    s_addc_u32 s27, s13, 0
    s_mov_b32 s3, 0x45f00000
    s_bitcmp1_b32 s38, 0
    s_cselect_b32 s3, 0x45d00000, s3
    v_mov_b32 v28, s3
    v_mov_b32 v5, 1
    s_waitcnt lgkmcnt(0)
    v_writelane_b32 v20, s44, 0
    v_writelane_b32 v20, s44, 1
    v_writelane_b32 v20, s45, 2
    v_writelane_b32 v20, s45, 3
    v_writelane_b32 v20, s46, 4
    v_writelane_b32 v20, s46, 5
    v_writelane_b32 v20, s47, 6
    v_writelane_b32 v20, s47, 7
    v_writelane_b32 v20, s48, 8
    v_writelane_b32 v20, s48, 9
    v_writelane_b32 v20, s49, 10
    v_writelane_b32 v20, s49, 11
    v_writelane_b32 v20, s50, 12
    v_writelane_b32 v20, s50, 13
    v_writelane_b32 v21, s52, 0
    v_writelane_b32 v21, s52, 1
    v_writelane_b32 v21, s53, 2
    v_writelane_b32 v21, s53, 3
    v_writelane_b32 v21, s54, 4
    v_writelane_b32 v21, s54, 5
    v_writelane_b32 v21, s55, 6
    v_writelane_b32 v21, s55, 7
    v_writelane_b32 v21, s56, 8
    v_writelane_b32 v21, s56, 9
    v_writelane_b32 v21, s57, 10
    v_writelane_b32 v21, s57, 11
    v_writelane_b32 v21, s58, 12
    v_writelane_b32 v21, s58, 13
    v_writelane_b32 v22, s60, 0
    v_writelane_b32 v22, s60, 1
    v_writelane_b32 v22, s61, 2
    v_writelane_b32 v22, s61, 3
    v_writelane_b32 v22, s62, 4
    v_writelane_b32 v22, s62, 5
    v_writelane_b32 v22, s63, 6
    v_writelane_b32 v22, s63, 7
    v_writelane_b32 v22, s64, 8
    v_writelane_b32 v22, s64, 9
    v_writelane_b32 v22, s65, 10
    v_writelane_b32 v22, s65, 11
    v_writelane_b32 v22, s66, 12
    v_writelane_b32 v22, s66, 13
    v_writelane_b32 v23, s68, 0
    v_writelane_b32 v23, s68, 1
    v_writelane_b32 v23, s69, 2
    v_writelane_b32 v23, s69, 3
    v_writelane_b32 v23, s70, 4
    v_writelane_b32 v23, s70, 5
    v_writelane_b32 v23, s71, 6
    v_writelane_b32 v23, s71, 7
    v_writelane_b32 v23, s72, 8
    v_writelane_b32 v23, s72, 9
    v_writelane_b32 v23, s73, 10
    v_writelane_b32 v23, s73, 11
    v_writelane_b32 v23, s74, 12
    v_writelane_b32 v23, s74, 13
    v_and_b32 v6, 1, v0
    v_lshlrev_b32 v6, 4, v6
    v_lshrrev_b32 v20, v6, v20
    v_lshrrev_b32 v21, v6, v21
    v_lshrrev_b32 v22, v6, v22
    v_lshrrev_b32 v23, v6, v23
    s_mov_b32 s33, 0
    s_mul_i32 s20, s20, 0x9E3779B1
    s_add_u32 s20, s20, 0x7F4A7C15
    s_mul_i32 s21, s21, 0x85EBCA6D
    s_add_u32 s21, s21, 0x2545F491
    v_add_u32 v29, 512, v1
    v_mov_b32 v24, 0x45e00000
    v_mov_b32 v25, 0x3d800000
    v_mov_b32 v26, 0x3d800000
    s_mov_b32 s32, s24
    s_mov_b32 s35, 0
    v_mov_b32 v27, s15
L_wait:
    ds_read_b32 v6, v4 offset:256
    ds_read_b64 v[16:17], v1
    s_waitcnt lgkmcnt(0)
    v_readfirstlane_b32 s3, v6
    s_cmp_eq_u32 s3, 8
    s_cbranch_scc1 L_got
    s_sleep 1
    s_branch L_wait
L_got:
    s_mov_b64 exec, 0xff
    v_mov_b32 v8, v16
    v_mov_b32 v13, s20
    v_mov_b32 v15, s21
    s_nop 1
    v_add_f32_dpp v8, v8, v8 row_shr:1 row_mask:0xf bank_mask:0xf bound_ctrl:0
    s_nop 1
    v_add_f32_dpp v8, v8, v8 row_shr:2 row_mask:0xf bank_mask:0xf bound_ctrl:0
    s_nop 1
    v_add_f32_dpp v8, v8, v8 row_shr:4 row_mask:0xf bank_mask:0xf bound_ctrl:0
    v_mul_f32 v8, 0x3e000000, v8
    s_nop 0
    v_readlane_b32 s28, v8, 7
    s_nop 1
    v_subrev_f32 v6, s28, v16
    v_mul_f32 v9, v24, v6
    v_fma_f32 v14, v9, v6, v17
    s_nop 1
    v_add_f32_dpp v14, v14, v14 row_shr:1 row_mask:0xf bank_mask:0xf bound_ctrl:0
    s_nop 1
    v_add_f32_dpp v14, v14, v14 row_shr:2 row_mask:0xf bank_mask:0xf bound_ctrl:0
    s_nop 1
    v_add_f32_dpp v14, v14, v14 row_shr:4 row_mask:0xf bank_mask:0xf bound_ctrl:0
    v_mov_b32 v12, s28
    s_mov_b64 exec, 0x80
    global_store_dwordx4 v27, v[12:15], s[26:27] sc1
    s_mov_b64 exec, -1
    s_mov_b32 s25, 3000
L_poll:
    s_load_dwordx16 s[36:51], s[26:27], 0x0 glc
    s_load_dwordx16 s[52:67], s[26:27], 0x40 glc
    s_load_dwordx16 s[68:83], s[26:27], 0x80 glc
    s_load_dwordx16 s[84:99], s[26:27], 0xc0 glc
    s_waitcnt lgkmcnt(0)
    s_xor_b32 s3, s37, s20
    s_xor_b32 s23, s39, s21
    s_or_b32 s3, s3, s23
    s_xor_b32 s23, s41, s20
    s_or_b32 s3, s3, s23
    s_xor_b32 s23, s43, s21
    s_or_b32 s3, s3, s23
    s_xor_b32 s23, s45, s20
    s_or_b32 s3, s3, s23
    s_xor_b32 s23, s47, s21
    s_or_b32 s3, s3, s23
    s_xor_b32 s23, s49, s20
    s_or_b32 s3, s3, s23
    s_xor_b32 s23, s51, s21
    s_or_b32 s3, s3, s23
    s_xor_b32 s23, s53, s20
    s_or_b32 s3, s3, s23
    s_xor_b32 s23, s55, s21
    s_or_b32 s3, s3, s23
    s_xor_b32 s23, s57, s20
    s_or_b32 s3, s3, s23
    s_xor_b32 s23, s59, s21
    s_or_b32 s3, s3, s23
    s_xor_b32 s23, s61, s20
    s_or_b32 s3, s3, s23
    s_xor_b32 s23, s63, s21
    s_or_b32 s3, s3, s23
    s_xor_b32 s23, s65, s20
    s_or_b32 s3, s3, s23
    s_xor_b32 s23, s67, s21
    s_or_b32 s3, s3, s23
    s_xor_b32 s23, s69, s20
    s_or_b32 s3, s3, s23
    s_xor_b32 s23, s71, s21
    s_or_b32 s3, s3, s23
    s_xor_b32 s23, s73, s20
    s_or_b32 s3, s3, s23
    s_xor_b32 s23, s75, s21
    s_or_b32 s3, s3, s23
    s_xor_b32 s23, s77, s20
    s_or_b32 s3, s3, s23
    s_xor_b32 s23, s79, s21
    s_or_b32 s3, s3, s23
    s_xor_b32 s23, s81, s20
    s_or_b32 s3, s3, s23
    s_xor_b32 s23, s83, s21
    s_or_b32 s3, s3, s23
    s_xor_b32 s23, s85, s20
    s_or_b32 s3, s3, s23
    s_xor_b32 s23, s87, s21
    s_or_b32 s3, s3, s23
    s_xor_b32 s23, s89, s20
    s_or_b32 s3, s3, s23
    s_xor_b32 s23, s91, s21
    s_or_b32 s3, s3, s23
    s_xor_b32 s23, s93, s20
    s_or_b32 s3, s3, s23
    s_xor_b32 s23, s95, s21
    s_or_b32 s3, s3, s23
    s_xor_b32 s23, s97, s20
    s_or_b32 s3, s3, s23
    s_xor_b32 s23, s99, s21
    s_or_b32 s3, s3, s23
    s_cbranch_scc0 L_ready
    s_sleep 1
    s_sub_u32 s25, s25, 1
    s_cmp_lg_u32 s25, 0
    s_cbranch_scc1 L_poll
    s_branch L_fallback
L_ready:
    v_mov_b32 v9, s36
    v_sub_f32 v11, s40, v9
    v_mov_b32 v10, 0
    v_mov_b32 v12, 0
    v_mul_f32 v13, v11, v11
    v_mov_b32 v14, s38
    v_mov_b32 v15, s42
    v_sub_f32 v16, s44, v9
    v_add_f32 v14, s46, v14
    v_add_f32 v10, v16, v10
    v_fma_f32 v12, v16, v16, v12
    v_sub_f32 v17, s48, v9
    v_add_f32 v15, s50, v15
    v_add_f32 v11, v17, v11
    v_fma_f32 v13, v17, v17, v13
    v_sub_f32 v16, s52, v9
    v_add_f32 v14, s54, v14
    v_add_f32 v10, v16, v10
    v_fma_f32 v12, v16, v16, v12
    v_sub_f32 v17, s56, v9
    v_add_f32 v15, s58, v15
    v_add_f32 v11, v17, v11
    v_fma_f32 v13, v17, v17, v13
    v_sub_f32 v16, s60, v9
    v_add_f32 v14, s62, v14
    v_add_f32 v10, v16, v10
    v_fma_f32 v12, v16, v16, v12
    v_sub_f32 v17, s64, v9
    v_add_f32 v15, s66, v15
    v_add_f32 v11, v17, v11
    v_fma_f32 v13, v17, v17, v13
    v_sub_f32 v16, s68, v9
    v_add_f32 v14, s70, v14
    v_add_f32 v10, v16, v10
    v_fma_f32 v12, v16, v16, v12
    v_sub_f32 v17, s72, v9
    v_add_f32 v15, s74, v15
    v_add_f32 v11, v17, v11
    v_fma_f32 v13, v17, v17, v13
    v_sub_f32 v16, s76, v9
    v_add_f32 v14, s78, v14
    v_add_f32 v10, v16, v10
    v_fma_f32 v12, v16, v16, v12
    v_sub_f32 v17, s80, v9
    v_add_f32 v15, s82, v15
    v_add_f32 v11, v17, v11
    v_fma_f32 v13, v17, v17, v13
    v_sub_f32 v16, s84, v9
    v_add_f32 v14, s86, v14
    v_add_f32 v10, v16, v10
    v_fma_f32 v12, v16, v16, v12
    v_sub_f32 v17, s88, v9
    v_add_f32 v15, s90, v15
    v_add_f32 v11, v17, v11
    v_fma_f32 v13, v17, v17, v13
    v_sub_f32 v16, s92, v9
    v_add_f32 v14, s94, v14
    v_add_f32 v10, v16, v10
    v_fma_f32 v12, v16, v16, v12
    v_sub_f32 v17, s96, v9
    v_add_f32 v15, s98, v15
    v_add_f32 v11, v17, v11
    v_fma_f32 v13, v17, v17, v13
    s_mov_b32 s33, 1
    v_mul_f32 v11, v26, v11
    v_mul_f32 v13, v26, v13
    v_fmac_f32 v11, v25, v10
    v_fmac_f32 v13, v25, v12
    v_add_f32 v14, v14, v15
    v_add_f32 v9, v9, v11
    v_fma_f32 v8, -v11, v11, v13
    v_fmac_f32 v8, 0x35924925, v14
L_fin:
    v_max_f32 v8, 0, v8
    v_cvt_pk_bf16_f32 v12, v9, v9
    v_lshlrev_b32 v12, 16, v12
    v_sub_f32 v13, v9, v12
    v_fma_f32 v8, v13, v13, v8
    v_cvt_pk_bf16_f32 v8, v8, v8
    v_lshlrev_b32 v8, 16, v8
    v_add_f32 v8, 0x3727c5ac, v8
    v_cvt_pk_bf16_f32 v8, v8, v8
    v_lshlrev_b32 v8, 16, v8
    v_sqrt_f32 v8, v8
    s_nop 0
    v_cvt_pk_bf16_f32 v8, v8, v8
    v_lshlrev_b32 v8, 16, v8
    v_rcp_f32 v8, v8
    v_lshlrev_b32 v6, 16, v20
    v_lshlrev_b32 v7, 16, v21
    v_mul_f32 v6, v8, v6
    v_fma_f32 v7, -v12, v6, v7
    s_mov_b64 exec, 0xffff
    ds_write_b64 v29, v[6:7]
    ds_write_b32 v4, v5 offset:272
    s_mov_b64 exec, -1
    s_cmp_lg_u32 s35, 0
    s_cbranch_scc1 L_last
    s_mov_b32 s35, 1
    s_add_u32 s26, s26, 256
    s_addc_u32 s27, s27, 0
    s_add_u32 s32, s24, 29360128
    v_mov_b32 v4, 4
    v_add_u32 v1, 64, v1
    v_add_u32 v29, 0x80, v29
    v_mov_b32 v20, v22
    v_mov_b32 v21, v23
    v_mov_b32 v24, v28
    v_mov_b32 v25, 0x3d892492
    v_mov_b32 v26, 0x3d6db6db
    s_branch L_wait
L_last:
    s_cmp_eq_u32 s33, 0
    s_cbranch_scc1 L_svc_done
    s_mov_b32 s16, s12
    s_mov_b32 s17, s13
    s_mov_b32 s18, 0x10000
    v_mov_b32 v6, s20
    v_mov_b32 v7, s21
    v_mov_b32 v8, s14
    s_mov_b64 exec, 1
    buffer_store_dwordx2 v[6:7], v8, s[16:19], 0 offen sc1
L_svc_done:
    s_endpgm
L_fallback:
    v_lshl_add_u32 v30, v0, 4, s32
    s_mov_b32 s23, 0xffff0000
    buffer_load_dword v31, v30, s[16:19], 0 offen
    s_mov_b32 s25, 0
    s_waitcnt vmcnt(0)
    v_readfirstlane_b32 s28, v31
    s_lshl_b32 s28, s28, 16
L_fb_sweep:
    v_mov_b32 v8, 0
    v_mov_b32 v9, 0
    v_mov_b32 v10, 0
    v_mov_b32 v11, 0
    v_mov_b32 v12, 0
    v_mov_b32 v13, 0
    v_mov_b32 v14, 0
    v_mov_b32 v15, 0
    s_mov_b32 s3, 0
L_fb_loop:
    buffer_load_dwordx4 v[32:35], v30, s[16:19], s3 offen offset:0
    buffer_load_dwordx4 v[36:39], v30, s[16:19], s3 offen offset:1024
    buffer_load_dwordx4 v[40:43], v30, s[16:19], s3 offen offset:2048
    buffer_load_dwordx4 v[44:47], v30, s[16:19], s3 offen offset:3072
    s_waitcnt vmcnt(0)
    v_lshlrev_b32 v48, 16, v32
    v_and_b32 v49, s23, v32
    v_lshlrev_b32 v50, 16, v33
    v_and_b32 v51, s23, v33
    v_lshlrev_b32 v52, 16, v34
    v_and_b32 v53, s23, v34
    v_lshlrev_b32 v54, 16, v35
    v_and_b32 v55, s23, v35
    v_lshlrev_b32 v56, 16, v36
    v_and_b32 v57, s23, v36
    v_lshlrev_b32 v58, 16, v37
    v_and_b32 v59, s23, v37
    v_lshlrev_b32 v60, 16, v38
    v_and_b32 v61, s23, v38
    v_lshlrev_b32 v62, 16, v39
    v_and_b32 v63, s23, v39
    v_lshlrev_b32 v64, 16, v40
    v_and_b32 v65, s23, v40
    v_lshlrev_b32 v66, 16, v41
    v_and_b32 v67, s23, v41
    v_lshlrev_b32 v68, 16, v42
    v_and_b32 v69, s23, v42
    v_lshlrev_b32 v70, 16, v43
    v_and_b32 v71, s23, v43
    v_lshlrev_b32 v72, 16, v44
    v_and_b32 v73, s23, v44
    v_lshlrev_b32 v74, 16, v45
    v_and_b32 v75, s23, v45
    v_lshlrev_b32 v76, 16, v46
    v_and_b32 v77, s23, v46
    v_lshlrev_b32 v78, 16, v47
    v_and_b32 v79, s23, v47
    v_pk_add_f32 v[48:49], v[48:49], s[28:29] op_sel_hi:[1,0] neg_lo:[0,1] neg_hi:[0,1]
    v_pk_add_f32 v[50:51], v[50:51], s[28:29] op_sel_hi:[1,0] neg_lo:[0,1] neg_hi:[0,1]
    v_pk_add_f32 v[52:53], v[52:53], s[28:29] op_sel_hi:[1,0] neg_lo:[0,1] neg_hi:[0,1]
    v_pk_add_f32 v[54:55], v[54:55], s[28:29] op_sel_hi:[1,0] neg_lo:[0,1] neg_hi:[0,1]
    v_pk_add_f32 v[56:57], v[56:57], s[28:29] op_sel_hi:[1,0] neg_lo:[0,1] neg_hi:[0,1]
    v_pk_add_f32 v[58:59], v[58:59], s[28:29] op_sel_hi:[1,0] neg_lo:[0,1] neg_hi:[0,1]
    v_pk_add_f32 v[60:61], v[60:61], s[28:29] op_sel_hi:[1,0] neg_lo:[0,1] neg_hi:[0,1]
    v_pk_add_f32 v[62:63], v[62:63], s[28:29] op_sel_hi:[1,0] neg_lo:[0,1] neg_hi:[0,1]
    v_pk_add_f32 v[64:65], v[64:65], s[28:29] op_sel_hi:[1,0] neg_lo:[0,1] neg_hi:[0,1]
    v_pk_add_f32 v[66:67], v[66:67], s[28:29] op_sel_hi:[1,0] neg_lo:[0,1] neg_hi:[0,1]
    v_pk_add_f32 v[68:69], v[68:69], s[28:29] op_sel_hi:[1,0] neg_lo:[0,1] neg_hi:[0,1]
    v_pk_add_f32 v[70:71], v[70:71], s[28:29] op_sel_hi:[1,0] neg_lo:[0,1] neg_hi:[0,1]
    v_pk_add_f32 v[72:73], v[72:73], s[28:29] op_sel_hi:[1,0] neg_lo:[0,1] neg_hi:[0,1]
    v_pk_add_f32 v[74:75], v[74:75], s[28:29] op_sel_hi:[1,0] neg_lo:[0,1] neg_hi:[0,1]
    v_pk_add_f32 v[76:77], v[76:77], s[28:29] op_sel_hi:[1,0] neg_lo:[0,1] neg_hi:[0,1]
    v_pk_add_f32 v[78:79], v[78:79], s[28:29] op_sel_hi:[1,0] neg_lo:[0,1] neg_hi:[0,1]
    v_pk_add_f32 v[8:9], v[8:9], v[48:49]
    v_pk_fma_f32 v[12:13], v[48:49], v[48:49], v[12:13]
    v_pk_add_f32 v[10:11], v[10:11], v[50:51]
    v_pk_fma_f32 v[14:15], v[50:51], v[50:51], v[14:15]
    v_pk_add_f32 v[8:9], v[8:9], v[52:53]
    v_pk_fma_f32 v[12:13], v[52:53], v[52:53], v[12:13]
    v_pk_add_f32 v[10:11], v[10:11], v[54:55]
    v_pk_fma_f32 v[14:15], v[54:55], v[54:55], v[14:15]
    v_pk_add_f32 v[8:9], v[8:9], v[56:57]
    v_pk_fma_f32 v[12:13], v[56:57], v[56:57], v[12:13]
    v_pk_add_f32 v[10:11], v[10:11], v[58:59]
    v_pk_fma_f32 v[14:15], v[58:59], v[58:59], v[14:15]
    v_pk_add_f32 v[8:9], v[8:9], v[60:61]
    v_pk_fma_f32 v[12:13], v[60:61], v[60:61], v[12:13]
    v_pk_add_f32 v[10:11], v[10:11], v[62:63]
    v_pk_fma_f32 v[14:15], v[62:63], v[62:63], v[14:15]
    v_pk_add_f32 v[8:9], v[8:9], v[64:65]
    v_pk_fma_f32 v[12:13], v[64:65], v[64:65], v[12:13]
    v_pk_add_f32 v[10:11], v[10:11], v[66:67]
    v_pk_fma_f32 v[14:15], v[66:67], v[66:67], v[14:15]
    v_pk_add_f32 v[8:9], v[8:9], v[68:69]
    v_pk_fma_f32 v[12:13], v[68:69], v[68:69], v[12:13]
    v_pk_add_f32 v[10:11], v[10:11], v[70:71]
    v_pk_fma_f32 v[14:15], v[70:71], v[70:71], v[14:15]
    v_pk_add_f32 v[8:9], v[8:9], v[72:73]
    v_pk_fma_f32 v[12:13], v[72:73], v[72:73], v[12:13]
    v_pk_add_f32 v[10:11], v[10:11], v[74:75]
    v_pk_fma_f32 v[14:15], v[74:75], v[74:75], v[14:15]
    v_pk_add_f32 v[8:9], v[8:9], v[76:77]
    v_pk_fma_f32 v[12:13], v[76:77], v[76:77], v[12:13]
    v_pk_add_f32 v[10:11], v[10:11], v[78:79]
    v_pk_fma_f32 v[14:15], v[78:79], v[78:79], v[14:15]
    s_add_u32 s3, s3, 4096
    s_cmp_lt_u32 s3, 1835008
    s_cbranch_scc1 L_fb_loop
    v_pk_add_f32 v[8:9], v[8:9], v[10:11]
    v_pk_add_f32 v[12:13], v[12:13], v[14:15]
    s_nop 0
    v_add_f32 v8, v8, v9
    v_add_f32 v12, v12, v13
    s_nop 0
    v_add_f32_dpp v8, v8, v8 row_shr:1 row_mask:0xf bank_mask:0xf bound_ctrl:0
    v_add_f32_dpp v12, v12, v12 row_shr:1 row_mask:0xf bank_mask:0xf bound_ctrl:0
    s_nop 0
    v_add_f32_dpp v8, v8, v8 row_shr:2 row_mask:0xf bank_mask:0xf bound_ctrl:0
    v_add_f32_dpp v12, v12, v12 row_shr:2 row_mask:0xf bank_mask:0xf bound_ctrl:0
    s_nop 0
    v_add_f32_dpp v8, v8, v8 row_shr:4 row_mask:0xf bank_mask:0xf bound_ctrl:0
    v_add_f32_dpp v12, v12, v12 row_shr:4 row_mask:0xf bank_mask:0xf bound_ctrl:0
    s_nop 0
    v_add_f32_dpp v8, v8, v8 row_shr:8 row_mask:0xf bank_mask:0xf bound_ctrl:0
    v_add_f32_dpp v12, v12, v12 row_shr:8 row_mask:0xf bank_mask:0xf bound_ctrl:0
    s_nop 0
    v_add_f32_dpp v8, v8, v8 row_bcast:15 row_mask:0xa bank_mask:0xf
    v_add_f32_dpp v12, v12, v12 row_bcast:15 row_mask:0xa bank_mask:0xf
    s_nop 0
    v_add_f32_dpp v8, v8, v8 row_bcast:31 row_mask:0xc bank_mask:0xf
    v_add_f32_dpp v12, v12, v12 row_bcast:31 row_mask:0xc bank_mask:0xf
    s_nop 0
    v_readlane_b32 s29, v8, 63
    v_readlane_b32 s30, v12, 63
    v_mov_b32 v10, 0x35924925
    s_nop 0
    v_mul_f32 v11, s29, v10
    v_mul_f32 v8, s30, v10
    v_fma_f32 v8, -v11, v11, v8
    v_add_f32 v9, s28, v11
    s_xor_b32 s25, s25, 1
    v_readfirstlane_b32 s28, v9
    s_cbranch_scc1 L_fb_sweep
    s_branch L_fin
L_end:
    s_endpgm
.section .rodata,"a"
.p2align 6
.amdhsa_kernel standalone__groupnorm__prompt_kernel
  .amdhsa_next_free_vgpr 149
  .amdhsa_next_free_sgpr 100
  .amdhsa_accum_offset 152
  .amdhsa_group_segment_fixed_size 0
  .amdhsa_kernarg_size 48
  .amdhsa_user_sgpr_count 2
  .amdhsa_user_sgpr_kernarg_segment_ptr 1
  .amdhsa_system_sgpr_workgroup_id_x 1
  .amdhsa_float_denorm_mode_32 3
.end_amdhsa_kernel
```
